```python
import torch

def _softmax(x, axis=-1):
    return torch.softmax(x, dim=axis)
def _gelu(x):
    return torch.nn.functional.gelu(x, approximate="tanh")
def _silu(x):
    return torch.nn.functional.silu(x)
def _sigmoid(x):
    return torch.sigmoid(x)
def _layernorm(x, axis=-1, eps=1e-5):
    m = x.mean(dim=axis, keepdim=True)
    v = x.var(dim=axis, keepdim=True, unbiased=False)
    return (x - m) / torch.sqrt(v + eps)
def _scatter_add(tgt, idx, src, axis=0):
    return tgt.clone().index_add_(axis, idx, src)
def _segment_sum(src, seg, n):
    out = torch.zeros((n,) + src.shape[1:], dtype=src.dtype)
    return out.index_add_(0, seg, src)
def _pad(x, pw):
    flat = tuple(v for pair in reversed(pw) for v in pair)
    return torch.nn.functional.pad(x, flat)

kernel_name = 'interleave_layers__linear_kernel_hedgehog__spectral_fnet__prompt'

def setup_inputs():

    _w = (lambda a: (lambda t: t.to(torch.bfloat16) if t.is_floating_point() else t)(torch.as_tensor(a)))
    def _A_setup():
        B, S, D, H = 1, 2048, 640, 32
        Dh = D // H
        return {
            "x": _w((lambda *s: torch.randn(*s, dtype=torch.bfloat16) * 0.4)(B, S, D)),
            "wqkv": _w((lambda *s: torch.randn(*s, dtype=torch.bfloat16) * 1.6)(D, 3 * D)),
            "w_phi": _w((lambda *s: torch.randn(*s, dtype=torch.bfloat16) * 1.6)(H, Dh, Dh) * (Dh ** -0.5)),
            "wo": _w((lambda *s: torch.randn(*s, dtype=torch.bfloat16) * 1.6)(D, D)),
        }
    _A_in = _A_setup()

    def _B_setup():
        B, S, D = 1, 2048, 640
        ns = torch.arange(S)[:, None] * torch.arange(S)[None, :]
        nd = torch.arange(D)[:, None] * torch.arange(D)[None, :]
        Ws_re = torch.cos(-2.0 * torch.pi * ns / S).to(float)
        Ws_im = torch.sin(-2.0 * torch.pi * ns / S).to(float)
        Wd_re = torch.cos(-2.0 * torch.pi * nd / D).to(float)
        Wd_im = torch.sin(-2.0 * torch.pi * nd / D).to(float)
        return {
            "x": _w((lambda *s: torch.randn(*s, dtype=torch.bfloat16) * 0.4)(B, S, D)),
            "dft_seq_re": _w(Ws_re),
            "dft_seq_im": _w(Ws_im),
            "dft_hid_re": _w(Wd_re),
            "dft_hid_im": _w(Wd_im),
        }
    _B_in = _B_setup()

    return {
        "A_x": _A_in["x"],
        "A_wqkv": _A_in["wqkv"],
        "A_w_phi": _A_in["w_phi"],
        "A_wo": _A_in["wo"],
        "B_x": _B_in["x"],
        "B_dft_seq_re": _B_in["dft_seq_re"],
        "B_dft_seq_im": _B_in["dft_seq_im"],
        "B_dft_hid_re": _B_in["dft_hid_re"],
        "B_dft_hid_im": _B_in["dft_hid_im"],
    }

def reference(A_x, A_wqkv, A_w_phi, A_wo, B_x, B_dft_seq_re, B_dft_seq_im, B_dft_hid_re, B_dft_hid_im):
    def _A_ref(x, wqkv, w_phi, wo):
        B, S, D = x.shape
        H = 32; Dh = D // H
        qkv = (lambda x, *d: x.permute(*d))((x @ wqkv).reshape(B, S, 3, H, Dh), 2, 0, 3, 1, 4)
        q, k, v = qkv[0], qkv[1], qkv[2]
        pq = torch.einsum("bhsd,hdf->bhsf", q, w_phi)
        pk = torch.einsum("bhsd,hdf->bhsf", k, w_phi)
        phi_q = torch.concatenate([_softmax(pq, axis=-1), _softmax(-pq, axis=-1)], axis=-1)
        phi_k = torch.concatenate([_softmax(pk, axis=-1), _softmax(-pk, axis=-1)], axis=-1)
        kv = torch.einsum("bhsf,bhsd->bhfd", phi_k, v)
        z  = torch.einsum("bhsf->bhf", phi_k)
        num = torch.einsum("bhqf,bhfd->bhqd", phi_q, kv)
        den = torch.einsum("bhqf,bhf->bhq", phi_q, z)[..., None] + 1e-6
        o = num / den
        return (lambda x, *d: x.permute(*d))(o, 0, 2, 1, 3).reshape(B, S, D) @ wo

    def _B_ref(x, dft_seq_re, dft_seq_im, dft_hid_re, dft_hid_im):
        a = torch.einsum("bsd,ed->bse", x, dft_hid_re)
        b = torch.einsum("bsd,ed->bse", x, dft_hid_im)
        y = torch.einsum("ts,bse->bte", dft_seq_re, a) - torch.einsum("ts,bse->bte", dft_seq_im, b)
        return y

    x = A_x
    x = x + _A_ref(_layernorm(x, axis=-1), A_wqkv, A_w_phi, A_wo)
    x = x + _B_ref(_layernorm(x, axis=-1), B_dft_seq_re, B_dft_seq_im, B_dft_hid_re, B_dft_hid_im)
    x = x + _A_ref(_layernorm(x, axis=-1), A_wqkv, A_w_phi, A_wo)
    x = x + _B_ref(_layernorm(x, axis=-1), B_dft_seq_re, B_dft_seq_im, B_dft_hid_re, B_dft_hid_im)
    return x
```

```asm
; @launch kernel=k0_kernel grid=(256,1,1) block=(256,1,1) lds=153664
; @launch kernel=kAl0_kernel grid=(256,1,1) block=(256,1,1) lds=163840
; @launch kernel=k3l0_kernel grid=(160,1,1) block=(576,1,1) lds=48384
; @launch kernel=kAl1_kernel grid=(256,1,1) block=(256,1,1) lds=163840
; @launch kernel=k3l1_kernel grid=(256,1,1) block=(576,1,1) lds=48384
.amdgcn_target "amdgcn-amd-amdhsa--gfx950"
.text
.p2align 8
prog_start:
.text
.globl k0_kernel
.p2align 8
.type k0_kernel,@function
k0_kernel:
    s_cmp_ge_u32 s2, 256
    s_cbranch_scc1 k0_kernel_exit
    s_getpc_b64 s[20:21]
k0_kernel_pc:
    s_sub_u32 s20, s20, k0_kernel_pc-prog_start
    s_subb_u32 s21, s21, 0
    s_lshr_b32 s3, s2, 3
    s_mul_i32 s3, s3, 1536
    v_lshlrev_b32 v5, 7, v0
    v_add_u32 v5, s3, v5
    v_min_u32 v5, prog_end-prog_start-4, v5
    v_cmp_gt_u32 vcc, 12, v0
    s_nop 0
    s_and_saveexec_b64 s[22:23], vcc
    s_cbranch_execz k0_kernel_nopf
    global_load_dword v239, v5, s[20:21]
k0_kernel_nopf:
    s_mov_b64 exec, s[22:23]
    s_load_dwordx4 s[4:7], s[0:1], 8
    s_load_dwordx2 s[8:9], s[0:1], 24
    s_load_dwordx4 s[12:15], s[0:1], 56
    s_load_dwordx2 s[16:17], s[0:1], 88
    s_load_dwordx2 s[44:45], s[0:1], 0
    v_and_b32 v1, 63, v0
    v_lshrrev_b32 v2, 6, v0
    v_and_b32 v3, 15, v1
    v_lshrrev_b32 v4, 4, v1
    v_readfirstlane_b32 s18, v2
    v_mov_b32 v14, 1073741824
    s_and_b32 s29, s2, 7
    s_lshl_b32 s29, s29, 5
    s_lshr_b32 s28, s2, 3
    s_add_u32 s29, s29, s28
    s_lshr_b32 s28, s29, 1
    s_and_b32 s29, s29, 1
    s_lshr_b32 s30, s28, 3
    s_bfe_u32 s31, s28, 0x20001
    s_and_b32 s46, s28, 1
    s_and_b32 s47, s30, 1
    s_lshl_b32 s47, s47, 10
    s_lshl_b32 s46, s46, 5
    s_add_u32 s47, s47, s46
    s_lshr_b32 s30, s30, 1
    s_lshl_b32 s30, s30, 2
    s_add_u32 s47, s47, s30
    s_add_u32 s47, s47, s31
    s_mul_i32 s47, s47, 1280
    s_mul_i32 s46, s29, 640
    s_add_u32 s47, s47, s46
    s_mul_i32 s46, s28, 20480
    s_mul_i32 s30, s29, 10240
    s_add_u32 s46, s46, s30
    s_add_u32 s46, s46, 13926400
    v_add_u32 v8, 0, v0
    v_mul_u32_u24 v9, 52429, v8
    v_lshrrev_b32 v9, 21, v9
    v_mul_u32_u24 v10, 40, v9
    v_sub_u32 v10, v8, v10
    v_mul_u32_u24 v11, 81920, v9
    v_lshl_add_u32 v212, v10, 4, v11
    v_lshlrev_b32 v12, 4, v9
    v_lshl_add_u32 v12, v10, 8, v12
    v_add_u32 v216, 143360, v12
    v_add_u32 v8, 256, v0
    v_mul_u32_u24 v9, 52429, v8
    v_lshrrev_b32 v9, 21, v9
    v_mul_u32_u24 v10, 40, v9
    v_sub_u32 v10, v8, v10
    v_mul_u32_u24 v11, 81920, v9
    v_lshl_add_u32 v213, v10, 4, v11
    v_lshlrev_b32 v12, 4, v9
    v_lshl_add_u32 v12, v10, 8, v12
    v_add_u32 v217, 143360, v12
    v_add_u32 v8, 512, v0
    v_mul_u32_u24 v9, 52429, v8
    v_lshrrev_b32 v9, 21, v9
    v_mul_u32_u24 v10, 40, v9
    v_sub_u32 v10, v8, v10
    v_mul_u32_u24 v11, 81920, v9
    v_lshl_add_u32 v214, v10, 4, v11
    v_lshlrev_b32 v12, 4, v9
    v_lshl_add_u32 v12, v10, 8, v12
    v_add_u32 v218, 143360, v12
    v_cmp_gt_u32 vcc, 640, v8
    s_nop 1
    v_cndmask_b32 v214, v14, v214, vcc
    s_lshr_b32 s56, s2, 4
    s_and_b32 s57, s2, 15
    s_mul_i32 s30, s57, 200
    v_add_u32 v8, s30, v0
    v_lshrrev_b32 v9, 4, v8
    v_mul_u32_u24 v10, 52429, v9
    v_lshrrev_b32 v10, 20, v10
    v_mul_u32_u24 v11, 20, v10
    v_sub_u32 v11, v9, v11
    s_lshr_b32 s57, s57, 3
    s_mul_i32 s30, s57, 5
    v_subrev_u32 v10, s30, v10
    v_and_b32 v12, 3, v8
    v_bfe_u32 v13, v8, 2, 2
    v_lshl_add_u32 v9, v10, 2, v12
    v_mul_u32_u24 v9, 1280, v9
    v_lshl_add_u32 v9, v11, 6, v9
    v_lshl_add_u32 v215, v13, 4, v9
    v_lshl_add_u32 v9, v10, 2, v12
    v_cmp_le_u32 vcc, 10, v9
    s_nop 1
    v_cndmask_b32 v10, 10, 0, vcc
    v_add_u32 v9, v9, v10
    v_cndmask_b32 v10, 0, 64, vcc
    v_and_b32 v12, 3, v9
    v_lshl_add_u32 v10, v12, 4, v10
    v_lshl_add_u32 v10, v13, 8, v10
    v_lshrrev_b32 v9, 2, v9
    v_mul_u32_u24 v12, 3072, v11
    v_add_u32 v12, 2048, v12
    v_lshlrev_b32 v13, 11, v11
    v_lshl_add_u32 v13, v9, 10, v13
    v_add_u32 v13, 58368, v13
    v_cmp_eq_u32 vcc, 2, v9
    s_nop 1
    v_cndmask_b32 v12, v13, v12, vcc
    v_add_u32 v219, v10, v12
    v_cmp_gt_u32 vcc, 200, v0
    s_nop 1
    v_cndmask_b32 v215, v14, v215, vcc
    v_cndmask_b32 v219, v14, v219, vcc
    s_mul_i32 s59, s56, 20
    s_add_u32 s59, s59, 1
    s_mul_i32 s59, s59, 1280
    s_mul_i32 s58, s56, 204800
    s_add_u32 s58, s58, 102400
    s_lshl_b32 s30, s57, 7
    s_add_u32 s58, s58, s30
    s_waitcnt lgkmcnt(0)
    s_mov_b32 s24, s16
    s_mov_b32 s25, s17
    s_mov_b32 s26, 28114944
    s_mov_b32 s27, 0x20000
    s_mov_b32 s48, s44
    s_mov_b32 s49, s45
    s_mov_b32 s50, 2621440
    s_mov_b32 s51, 0x20000
    s_cmp_eq_u32 s57, 1
    s_cselect_b32 s40, s14, s12
    s_cselect_b32 s41, s15, s13
    s_mov_b32 s42, 819200
    s_mov_b32 s43, 0x20000
    buffer_load_dwordx4 v[232:235], v215, s[40:43], s59 offen
    s_cmp_ge_u32 s2, 20
    s_cselect_b32 s19, 11546624, 0
    s_add_u32 s19, s19, 4980736
    s_lshl_b32 s30, s2, 10
    s_add_u32 s19, s19, s30
    v_mov_b32 v200, 0
    v_mov_b32 v201, 0
    v_mov_b32 v202, 0
    v_mov_b32 v203, 0
    s_cmp_lt_u32 s2, 40
    s_cselect_b32 s30, 64, 0
    v_lshlrev_b32 v6, 4, v0
    v_cmp_gt_u32 vcc, s30, v0
    s_nop 1
    v_cndmask_b32 v7, v14, v6, vcc
    buffer_store_dwordx4 v[200:203], v7, s[24:27], s19 offen sc1
    s_and_b32 s33, s2, 7
    s_lshr_b32 s34, s2, 3
    s_cmp_ge_u32 s34, 12
    s_cbranch_scc1 k0_kernel_wf
    buffer_load_dwordx4 v[220:223], v212, s[48:51], s47 offen
    buffer_load_dwordx4 v[224:227], v213, s[48:51], s47 offen
    buffer_load_dwordx4 v[228:231], v214, s[48:51], s47 offen
    s_mul_i32 s30, s33, 12
    s_add_u32 s30, s30, s34
    s_lshr_b32 s28, s30, 5
    s_and_b32 s29, s30, 31
    s_mov_b32 s32, s4
    s_mov_b32 s33, s5
    s_mov_b32 s34, 2457600
    s_mov_b32 s35, 0x20000
    s_mov_b32 s36, s6
    s_mov_b32 s37, s7
    s_mov_b32 s38, 25600
    s_mov_b32 s39, 0x20000
    v_lshrrev_b32 v8, 2, v1
    v_lshrrev_b32 v9, 4, v1
    v_xor_b32 v9, v9, v1
    v_and_b32 v9, 3, v9
    s_mul_i32 s30, s18, 160
    v_add_u32 v8, s30, v8
    s_movk_i32 s31, 3840
    v_mul_lo_u32 v8, v8, s31
    s_mul_i32 s30, s28, 640
    s_mul_i32 s31, s29, 20
    s_add_u32 s30, s30, s31
    s_lshl_b32 s30, s30, 1
    v_lshlrev_b32 v9, 4, v9
    v_add3_u32 v8, v8, v9, s30
    v_lshlrev_b32 v10, 4, v0
    v_cmp_gt_u32 vcc, 50, v0
    s_nop 1
    v_cndmask_b32 v11, v14, v10, vcc
    s_mul_i32 s30, s29, 800
    buffer_load_dwordx4 v[64:67], v11, s[36:39], s30 offen
    s_mov_b32 s31, 0
    s_mul_i32 s55, s18, 10240
    s_add_u32 s55, s55, 4096
    s_add_u32 m0, s55, 0
    s_nop 0
    buffer_load_dwordx4 v8, s[32:35], s31 offen lds
    s_add_u32 s31, s31, 61440
    s_add_u32 m0, s55, 1024
    s_nop 0
    buffer_load_dwordx4 v8, s[32:35], s31 offen lds
    s_add_u32 s31, s31, 61440
    s_add_u32 m0, s55, 2048
    s_nop 0
    buffer_load_dwordx4 v8, s[32:35], s31 offen lds
    s_add_u32 s31, s31, 61440
    s_add_u32 m0, s55, 3072
    s_nop 0
    buffer_load_dwordx4 v8, s[32:35], s31 offen lds
    s_add_u32 s31, s31, 61440
    s_add_u32 m0, s55, 4096
    s_nop 0
    buffer_load_dwordx4 v8, s[32:35], s31 offen lds
    s_add_u32 s31, s31, 61440
    s_add_u32 m0, s55, 5120
    s_nop 0
    buffer_load_dwordx4 v8, s[32:35], s31 offen lds
    s_add_u32 s31, s31, 61440
    s_add_u32 m0, s55, 6144
    s_nop 0
    buffer_load_dwordx4 v8, s[32:35], s31 offen lds
    s_add_u32 s31, s31, 61440
    s_add_u32 m0, s55, 7168
    s_nop 0
    buffer_load_dwordx4 v8, s[32:35], s31 offen lds
    s_add_u32 s31, s31, 61440
    s_add_u32 m0, s55, 8192
    s_nop 0
    buffer_load_dwordx4 v8, s[32:35], s31 offen lds
    s_add_u32 s31, s31, 61440
    s_add_u32 m0, s55, 9216
    s_nop 0
    buffer_load_dwordx4 v8, s[32:35], s31 offen lds
    v_lshrrev_b32 v12, 2, v3
    v_xor_b32 v12, v12, v4
    v_lshlrev_b32 v12, 4, v12
    v_lshl_add_u32 v12, v3, 6, v12
    v_add_u32 v12, s55, v12
    v_mov_b32 v68, 0
    v_mov_b32 v69, 0
    v_mov_b32 v70, 0
    v_mov_b32 v71, 0
    v_cmp_gt_u32 vcc, 84, v0
    s_nop 0
    s_and_saveexec_b64 s[52:53], vcc
    ds_write_b128 v10, v[68:71]
    s_mov_b64 exec, s[52:53]
    s_waitcnt vmcnt(11)
    buffer_store_dwordx4 v[232:235], v219, s[24:27], s58 offen sc1
    ds_write_b128 v216, v[220:223]
    ds_write_b128 v217, v[224:227]
    v_cmp_gt_u32 vcc, 128, v0
    s_nop 0
    s_and_saveexec_b64 s[52:53], vcc
    ds_write_b128 v218, v[228:231]
    s_mov_b64 exec, s[52:53]
    s_waitcnt lgkmcnt(0)
    s_barrier
    v_lshlrev_b32 v236, 4, v0
    v_add_u32 v237, 143360, v236
    ds_read_b128 v[220:223], v237 offset:0
    ds_read_b128 v[224:227], v237 offset:4096
    ds_read_b128 v[228:231], v237 offset:8192
    v_mov_b32 v238, 1073741824
    v_cmp_gt_u32 vcc, 128, v0
    s_nop 1
    v_cndmask_b32 v237, v238, v236, vcc
    s_waitcnt lgkmcnt(0)
    buffer_store_dwordx4 v[220:223], v236, s[24:27], s46 offen sc1
    s_add_u32 s46, s46, 4096
    buffer_store_dwordx4 v[224:227], v236, s[24:27], s46 offen sc1
    s_add_u32 s46, s46, 4096
    buffer_store_dwordx4 v[228:231], v237, s[24:27], s46 offen sc1
    s_cmp_eq_u32 s28, 2
    s_cbranch_scc1 k0_kernel_bid
    s_waitcnt vmcnt(14)
    v_cmp_gt_u32 vcc, 50, v0
    s_nop 0
    s_and_saveexec_b64 s[52:53], vcc
    ds_write_b128 v10, v[64:67]
    s_mov_b64 exec, s[52:53]
    s_branch k0_kernel_bdone
k0_kernel_bid:
    v_mul_u32_u24 v10, 42, v0
    v_mov_b32 v11, 0x3f80
    v_cmp_gt_u32 vcc, 20, v0
    s_nop 0
    s_and_saveexec_b64 s[52:53], vcc
    ds_write_b16 v10, v11
    s_mov_b64 exec, s[52:53]
k0_kernel_bdone:
    s_waitcnt lgkmcnt(0)
    s_barrier
    v_lshrrev_b32 v10, 2, v3
    v_lshl_add_u32 v10, v4, 3, v10
    v_mul_u32_u24 v10, 40, v10
    v_and_b32 v11, 3, v1
    v_lshl_add_u32 v10, v11, 3, v10
    ds_read_b64_tr_b16 v[56:57], v10 offset:0
    ds_read_b64_tr_b16 v[58:59], v10 offset:160
    ds_read_b64_tr_b16 v[60:61], v10 offset:32
    ds_read_b64_tr_b16 v[62:63], v10 offset:192
    s_waitcnt vmcnt(4)
    ds_read_b128 v[16:19], v12 offset:0
    ds_read_b128 v[20:23], v12 offset:1024
    ds_read_b128 v[24:27], v12 offset:2048
    ds_read_b128 v[28:31], v12 offset:3072
    ds_read_b128 v[32:35], v12 offset:4096
    ds_read_b128 v[36:39], v12 offset:5120
    ds_read_b128 v[40:43], v12 offset:6144
    ds_read_b128 v[44:47], v12 offset:7168
    ds_read_b128 v[48:51], v12 offset:8192
    ds_read_b128 v[52:55], v12 offset:9216
    s_waitcnt lgkmcnt(0)
    v_mfma_f32_16x16x32_bf16 v[80:83], v[16:19], v[56:59], 0
    v_mfma_f32_16x16x32_bf16 v[84:87], v[16:19], v[60:63], 0
    v_mfma_f32_16x16x32_bf16 v[88:91], v[20:23], v[56:59], 0
    v_mfma_f32_16x16x32_bf16 v[92:95], v[20:23], v[60:63], 0
    v_mfma_f32_16x16x32_bf16 v[96:99], v[24:27], v[56:59], 0
    v_mfma_f32_16x16x32_bf16 v[100:103], v[24:27], v[60:63], 0
    v_mfma_f32_16x16x32_bf16 v[104:107], v[28:31], v[56:59], 0
    v_mfma_f32_16x16x32_bf16 v[108:111], v[28:31], v[60:63], 0
    v_mfma_f32_16x16x32_bf16 v[112:115], v[32:35], v[56:59], 0
    v_mfma_f32_16x16x32_bf16 v[116:119], v[32:35], v[60:63], 0
    v_mfma_f32_16x16x32_bf16 v[120:123], v[36:39], v[56:59], 0
    v_mfma_f32_16x16x32_bf16 v[124:127], v[36:39], v[60:63], 0
    v_mfma_f32_16x16x32_bf16 v[128:131], v[40:43], v[56:59], 0
    v_mfma_f32_16x16x32_bf16 v[132:135], v[40:43], v[60:63], 0
    v_mfma_f32_16x16x32_bf16 v[136:139], v[44:47], v[56:59], 0
    v_mfma_f32_16x16x32_bf16 v[140:143], v[44:47], v[60:63], 0
    v_mfma_f32_16x16x32_bf16 v[144:147], v[48:51], v[56:59], 0
    v_mfma_f32_16x16x32_bf16 v[148:151], v[48:51], v[60:63], 0
    v_mfma_f32_16x16x32_bf16 v[152:155], v[52:55], v[56:59], 0
    v_mfma_f32_16x16x32_bf16 v[156:159], v[52:55], v[60:63], 0
    v_pk_add_f32 v[64:65], v[80:81], v[82:83]
    v_pk_add_f32 v[64:65], v[64:65], v[88:89]
    v_pk_add_f32 v[64:65], v[64:65], v[90:91]
    v_pk_add_f32 v[64:65], v[64:65], v[96:97]
    v_pk_add_f32 v[64:65], v[64:65], v[98:99]
    v_pk_add_f32 v[64:65], v[64:65], v[104:105]
    v_pk_add_f32 v[64:65], v[64:65], v[106:107]
    v_pk_add_f32 v[64:65], v[64:65], v[112:113]
    v_pk_add_f32 v[64:65], v[64:65], v[114:115]
    v_pk_add_f32 v[64:65], v[64:65], v[120:121]
    v_pk_add_f32 v[64:65], v[64:65], v[122:123]
    v_pk_add_f32 v[64:65], v[64:65], v[128:129]
    v_pk_add_f32 v[64:65], v[64:65], v[130:131]
    v_pk_add_f32 v[64:65], v[64:65], v[136:137]
    v_pk_add_f32 v[64:65], v[64:65], v[138:139]
    v_pk_add_f32 v[64:65], v[64:65], v[144:145]
    v_pk_add_f32 v[64:65], v[64:65], v[146:147]
    v_pk_add_f32 v[64:65], v[64:65], v[152:153]
    v_pk_add_f32 v[64:65], v[64:65], v[154:155]
    v_add_f32 v64, v64, v65
    v_pk_add_f32 v[66:67], v[84:85], v[86:87]
    v_pk_add_f32 v[66:67], v[66:67], v[92:93]
    v_pk_add_f32 v[66:67], v[66:67], v[94:95]
    v_pk_add_f32 v[66:67], v[66:67], v[100:101]
    v_pk_add_f32 v[66:67], v[66:67], v[102:103]
    v_pk_add_f32 v[66:67], v[66:67], v[108:109]
    v_pk_add_f32 v[66:67], v[66:67], v[110:111]
    v_pk_add_f32 v[66:67], v[66:67], v[116:117]
    v_pk_add_f32 v[66:67], v[66:67], v[118:119]
    v_pk_add_f32 v[66:67], v[66:67], v[124:125]
    v_pk_add_f32 v[66:67], v[66:67], v[126:127]
    v_pk_add_f32 v[66:67], v[66:67], v[132:133]
    v_pk_add_f32 v[66:67], v[66:67], v[134:135]
    v_pk_add_f32 v[66:67], v[66:67], v[140:141]
    v_pk_add_f32 v[66:67], v[66:67], v[142:143]
    v_pk_add_f32 v[66:67], v[66:67], v[148:149]
    v_pk_add_f32 v[66:67], v[66:67], v[150:151]
    v_pk_add_f32 v[66:67], v[66:67], v[156:157]
    v_pk_add_f32 v[66:67], v[66:67], v[158:159]
    v_add_f32 v66, v66, v67
    v_mov_b32 v68, v64
    s_nop 1
    v_permlane32_swap_b32 v64, v68
    v_add_f32 v64, v64, v68
    v_mov_b32 v68, v64
    s_nop 1
    v_permlane16_swap_b32 v64, v68
    v_add_f32 v64, v64, v68
    v_mov_b32 v68, v66
    s_nop 1
    v_permlane32_swap_b32 v66, v68
    v_add_f32 v66, v66, v68
    v_mov_b32 v68, v66
    s_nop 1
    v_permlane16_swap_b32 v66, v68
    v_add_f32 v66, v66, v68
    v_lshlrev_b32 v69, 4, v3
    v_add_u32 v69, 2048, v69
    s_lshl_b32 s30, s18, 2
    v_add_u32 v70, s30, v69
    ds_write_b32 v70, v64
    ds_write_b32 v70, v66 offset:256
    s_and_b32 s30, s29, 1
    s_lshl_b32 s30, s30, 7
    v_and_b32 v8, 1, v4
    v_lshlrev_b32 v8, 9, v8
    v_lshrrev_b32 v9, 1, v4
    v_lshlrev_b32 v9, 8, v9
    v_add3_u32 v8, v8, v9, s30
    s_cmp_eq_u32 s28, 2
    s_cselect_b32 s31, 10, 0
    s_mul_i32 s30, s18, 5
    v_add_u32 v9, 0, v3
    v_cmp_le_u32 vcc, 10, v9
    s_nop 1
    v_cndmask_b32 v10, 0, 10, vcc
    v_sub_u32 v9, v9, v10
    v_add_u32 v9, s31, v9
    v_cndmask_b32 v10, 0, 64, vcc
    v_and_b32 v11, 3, v9
    v_lshl_add_u32 v10, v11, 4, v10
    v_lshrrev_b32 v9, 2, v9
    v_lshl_add_u32 v10, v9, 10, v10
    v_cmp_gt_u32 vcc, 3, v9
    v_mov_b32 v11, 58368
    s_nop 0
    v_cndmask_b32 v11, v11, 0, vcc
    v_add3_u32 v10, v8, v10, v11
    v_mov_b32 v11, 2048
    v_mov_b32 v9, 3072
    v_cndmask_b32 v78, v11, v9, vcc
    v_mul_u32_u24 v11, s30, v78
    v_add_u32 v72, v10, v11
    v_add_u32 v9, 16, v3
    v_cmp_le_u32 vcc, 10, v9
    s_nop 1
    v_cndmask_b32 v10, 0, 10, vcc
    v_sub_u32 v9, v9, v10
    v_add_u32 v9, s31, v9
    v_cndmask_b32 v10, 0, 64, vcc
    v_and_b32 v11, 3, v9
    v_lshl_add_u32 v10, v11, 4, v10
    v_lshrrev_b32 v9, 2, v9
    v_lshl_add_u32 v10, v9, 10, v10
    v_cmp_gt_u32 vcc, 3, v9
    v_mov_b32 v11, 58368
    s_nop 0
    v_cndmask_b32 v11, v11, 0, vcc
    v_add3_u32 v10, v8, v10, v11
    v_mov_b32 v11, 2048
    v_mov_b32 v9, 3072
    v_cndmask_b32 v79, v11, v9, vcc
    v_mul_u32_u24 v11, s30, v79
    v_add_u32 v73, v10, v11
    v_cmp_gt_u32 vcc, 4, v3
    s_nop 1
    v_cndmask_b32 v73, v14, v73, vcc
    s_lshr_b32 s30, s29, 1
    s_mul_i32 s30, s30, 204800
    s_cmp_eq_u32 s28, 0
    s_cselect_b32 s31, 102400, 0
    s_add_u32 s30, s30, s31
    s_waitcnt lgkmcnt(0)
    s_barrier
    ds_read_b128 v[68:71], v69
    ds_read_b128 v[74:77], v69 offset:256
    s_waitcnt lgkmcnt(0)
    v_pk_add_f32 v[68:69], v[68:69], v[70:71]
    v_add_f32 v68, v68, v69
    v_mul_f32 v64, 0.0015625, v68
    v_pk_add_f32 v[74:75], v[74:75], v[76:77]
    v_add_f32 v74, v74, v75
    v_mul_f32 v66, 0.0015625, v74
    v_pk_add_f32 v[80:81], v[80:81], v[64:65] op_sel_hi:[1,0] neg_lo:[0,1] neg_hi:[0,1]
    v_pk_add_f32 v[82:83], v[82:83], v[64:65] op_sel_hi:[1,0] neg_lo:[0,1] neg_hi:[0,1]
    v_pk_add_f32 v[88:89], v[88:89], v[64:65] op_sel_hi:[1,0] neg_lo:[0,1] neg_hi:[0,1]
    v_pk_add_f32 v[90:91], v[90:91], v[64:65] op_sel_hi:[1,0] neg_lo:[0,1] neg_hi:[0,1]
    v_cvt_pk_bf16_f32 v16, v80, v81
    v_cvt_pk_bf16_f32 v17, v82, v83
    v_cvt_pk_bf16_f32 v18, v88, v89
    v_cvt_pk_bf16_f32 v19, v90, v91
    s_nop 0
    v_permlane16_swap_b32 v16, v18
    v_permlane16_swap_b32 v17, v19
    buffer_store_dwordx4 v[16:19], v72, s[24:27], s30 offen sc1
    v_pk_add_f32 v[84:85], v[84:85], v[66:67] op_sel_hi:[1,0] neg_lo:[0,1] neg_hi:[0,1]
    v_pk_add_f32 v[86:87], v[86:87], v[66:67] op_sel_hi:[1,0] neg_lo:[0,1] neg_hi:[0,1]
    v_pk_add_f32 v[92:93], v[92:93], v[66:67] op_sel_hi:[1,0] neg_lo:[0,1] neg_hi:[0,1]
    v_pk_add_f32 v[94:95], v[94:95], v[66:67] op_sel_hi:[1,0] neg_lo:[0,1] neg_hi:[0,1]
    v_cvt_pk_bf16_f32 v20, v84, v85
    v_cvt_pk_bf16_f32 v21, v86, v87
    v_cvt_pk_bf16_f32 v22, v92, v93
    v_cvt_pk_bf16_f32 v23, v94, v95
    s_nop 0
    v_permlane16_swap_b32 v20, v22
    v_permlane16_swap_b32 v21, v23
    buffer_store_dwordx4 v[20:23], v73, s[24:27], s30 offen sc1
    v_add_u32 v72, v72, v78
    v_add_u32 v73, v73, v79
    v_pk_add_f32 v[96:97], v[96:97], v[64:65] op_sel_hi:[1,0] neg_lo:[0,1] neg_hi:[0,1]
    v_pk_add_f32 v[98:99], v[98:99], v[64:65] op_sel_hi:[1,0] neg_lo:[0,1] neg_hi:[0,1]
    v_pk_add_f32 v[104:105], v[104:105], v[64:65] op_sel_hi:[1,0] neg_lo:[0,1] neg_hi:[0,1]
    v_pk_add_f32 v[106:107], v[106:107], v[64:65] op_sel_hi:[1,0] neg_lo:[0,1] neg_hi:[0,1]
    v_cvt_pk_bf16_f32 v24, v96, v97
    v_cvt_pk_bf16_f32 v25, v98, v99
    v_cvt_pk_bf16_f32 v26, v104, v105
    v_cvt_pk_bf16_f32 v27, v106, v107
    s_nop 0
    v_permlane16_swap_b32 v24, v26
    v_permlane16_swap_b32 v25, v27
    buffer_store_dwordx4 v[24:27], v72, s[24:27], s30 offen sc1
    v_pk_add_f32 v[100:101], v[100:101], v[66:67] op_sel_hi:[1,0] neg_lo:[0,1] neg_hi:[0,1]
    v_pk_add_f32 v[102:103], v[102:103], v[66:67] op_sel_hi:[1,0] neg_lo:[0,1] neg_hi:[0,1]
    v_pk_add_f32 v[108:109], v[108:109], v[66:67] op_sel_hi:[1,0] neg_lo:[0,1] neg_hi:[0,1]
    v_pk_add_f32 v[110:111], v[110:111], v[66:67] op_sel_hi:[1,0] neg_lo:[0,1] neg_hi:[0,1]
    v_cvt_pk_bf16_f32 v28, v100, v101
    v_cvt_pk_bf16_f32 v29, v102, v103
    v_cvt_pk_bf16_f32 v30, v108, v109
    v_cvt_pk_bf16_f32 v31, v110, v111
    s_nop 0
    v_permlane16_swap_b32 v28, v30
    v_permlane16_swap_b32 v29, v31
    buffer_store_dwordx4 v[28:31], v73, s[24:27], s30 offen sc1
    v_add_u32 v72, v72, v78
    v_add_u32 v73, v73, v79
    v_pk_add_f32 v[112:113], v[112:113], v[64:65] op_sel_hi:[1,0] neg_lo:[0,1] neg_hi:[0,1]
    v_pk_add_f32 v[114:115], v[114:115], v[64:65] op_sel_hi:[1,0] neg_lo:[0,1] neg_hi:[0,1]
    v_pk_add_f32 v[120:121], v[120:121], v[64:65] op_sel_hi:[1,0] neg_lo:[0,1] neg_hi:[0,1]
    v_pk_add_f32 v[122:123], v[122:123], v[64:65] op_sel_hi:[1,0] neg_lo:[0,1] neg_hi:[0,1]
    v_cvt_pk_bf16_f32 v32, v112, v113
    v_cvt_pk_bf16_f32 v33, v114, v115
    v_cvt_pk_bf16_f32 v34, v120, v121
    v_cvt_pk_bf16_f32 v35, v122, v123
    s_nop 0
    v_permlane16_swap_b32 v32, v34
    v_permlane16_swap_b32 v33, v35
    buffer_store_dwordx4 v[32:35], v72, s[24:27], s30 offen sc1
    v_pk_add_f32 v[116:117], v[116:117], v[66:67] op_sel_hi:[1,0] neg_lo:[0,1] neg_hi:[0,1]
    v_pk_add_f32 v[118:119], v[118:119], v[66:67] op_sel_hi:[1,0] neg_lo:[0,1] neg_hi:[0,1]
    v_pk_add_f32 v[124:125], v[124:125], v[66:67] op_sel_hi:[1,0] neg_lo:[0,1] neg_hi:[0,1]
    v_pk_add_f32 v[126:127], v[126:127], v[66:67] op_sel_hi:[1,0] neg_lo:[0,1] neg_hi:[0,1]
    v_cvt_pk_bf16_f32 v36, v116, v117
    v_cvt_pk_bf16_f32 v37, v118, v119
    v_cvt_pk_bf16_f32 v38, v124, v125
    v_cvt_pk_bf16_f32 v39, v126, v127
    s_nop 0
    v_permlane16_swap_b32 v36, v38
    v_permlane16_swap_b32 v37, v39
    buffer_store_dwordx4 v[36:39], v73, s[24:27], s30 offen sc1
    v_add_u32 v72, v72, v78
    v_add_u32 v73, v73, v79
    v_pk_add_f32 v[128:129], v[128:129], v[64:65] op_sel_hi:[1,0] neg_lo:[0,1] neg_hi:[0,1]
    v_pk_add_f32 v[130:131], v[130:131], v[64:65] op_sel_hi:[1,0] neg_lo:[0,1] neg_hi:[0,1]
    v_pk_add_f32 v[136:137], v[136:137], v[64:65] op_sel_hi:[1,0] neg_lo:[0,1] neg_hi:[0,1]
    v_pk_add_f32 v[138:139], v[138:139], v[64:65] op_sel_hi:[1,0] neg_lo:[0,1] neg_hi:[0,1]
    v_cvt_pk_bf16_f32 v40, v128, v129
    v_cvt_pk_bf16_f32 v41, v130, v131
    v_cvt_pk_bf16_f32 v42, v136, v137
    v_cvt_pk_bf16_f32 v43, v138, v139
    s_nop 0
    v_permlane16_swap_b32 v40, v42
    v_permlane16_swap_b32 v41, v43
    buffer_store_dwordx4 v[40:43], v72, s[24:27], s30 offen sc1
    v_pk_add_f32 v[132:133], v[132:133], v[66:67] op_sel_hi:[1,0] neg_lo:[0,1] neg_hi:[0,1]
    v_pk_add_f32 v[134:135], v[134:135], v[66:67] op_sel_hi:[1,0] neg_lo:[0,1] neg_hi:[0,1]
    v_pk_add_f32 v[140:141], v[140:141], v[66:67] op_sel_hi:[1,0] neg_lo:[0,1] neg_hi:[0,1]
    v_pk_add_f32 v[142:143], v[142:143], v[66:67] op_sel_hi:[1,0] neg_lo:[0,1] neg_hi:[0,1]
    v_cvt_pk_bf16_f32 v44, v132, v133
    v_cvt_pk_bf16_f32 v45, v134, v135
    v_cvt_pk_bf16_f32 v46, v140, v141
    v_cvt_pk_bf16_f32 v47, v142, v143
    s_nop 0
    v_permlane16_swap_b32 v44, v46
    v_permlane16_swap_b32 v45, v47
    buffer_store_dwordx4 v[44:47], v73, s[24:27], s30 offen sc1
    v_add_u32 v72, v72, v78
    v_add_u32 v73, v73, v79
    v_pk_add_f32 v[144:145], v[144:145], v[64:65] op_sel_hi:[1,0] neg_lo:[0,1] neg_hi:[0,1]
    v_pk_add_f32 v[146:147], v[146:147], v[64:65] op_sel_hi:[1,0] neg_lo:[0,1] neg_hi:[0,1]
    v_pk_add_f32 v[152:153], v[152:153], v[64:65] op_sel_hi:[1,0] neg_lo:[0,1] neg_hi:[0,1]
    v_pk_add_f32 v[154:155], v[154:155], v[64:65] op_sel_hi:[1,0] neg_lo:[0,1] neg_hi:[0,1]
    v_cvt_pk_bf16_f32 v48, v144, v145
    v_cvt_pk_bf16_f32 v49, v146, v147
    v_cvt_pk_bf16_f32 v50, v152, v153
    v_cvt_pk_bf16_f32 v51, v154, v155
    s_nop 0
    v_permlane16_swap_b32 v48, v50
    v_permlane16_swap_b32 v49, v51
    buffer_store_dwordx4 v[48:51], v72, s[24:27], s30 offen sc1
    v_pk_add_f32 v[148:149], v[148:149], v[66:67] op_sel_hi:[1,0] neg_lo:[0,1] neg_hi:[0,1]
    v_pk_add_f32 v[150:151], v[150:151], v[66:67] op_sel_hi:[1,0] neg_lo:[0,1] neg_hi:[0,1]
    v_pk_add_f32 v[156:157], v[156:157], v[66:67] op_sel_hi:[1,0] neg_lo:[0,1] neg_hi:[0,1]
    v_pk_add_f32 v[158:159], v[158:159], v[66:67] op_sel_hi:[1,0] neg_lo:[0,1] neg_hi:[0,1]
    v_cvt_pk_bf16_f32 v52, v148, v149
    v_cvt_pk_bf16_f32 v53, v150, v151
    v_cvt_pk_bf16_f32 v54, v156, v157
    v_cvt_pk_bf16_f32 v55, v158, v159
    s_nop 0
    v_permlane16_swap_b32 v52, v54
    v_permlane16_swap_b32 v53, v55
    buffer_store_dwordx4 v[52:55], v73, s[24:27], s30 offen sc1
    v_mov_b32 v204, -1
    v_mov_b32 v205, -1
    v_mov_b32 v206, -1
    v_mov_b32 v207, -1
    s_mul_i32 s30, s2, 12288
    v_lshlrev_b32 v8, 4, v0
    v_add_u32 v8, s30, v8
    s_mov_b32 s31, 5013504
    v_mov_b32 v10, 1048576
    v_cmp_gt_u32 vcc, v10, v8
    s_nop 1
    v_cndmask_b32 v9, v14, v8, vcc
    buffer_store_dwordx4 v[204:207], v9, s[24:27], s31 offen sc1
    v_add_u32 v8, 4096, v8
    v_mov_b32 v10, 1048576
    v_cmp_gt_u32 vcc, v10, v8
    s_nop 1
    v_cndmask_b32 v9, v14, v8, vcc
    buffer_store_dwordx4 v[204:207], v9, s[24:27], s31 offen sc1
    v_add_u32 v8, 4096, v8
    v_mov_b32 v10, 1048576
    v_cmp_gt_u32 vcc, v10, v8
    s_nop 1
    v_cndmask_b32 v9, v14, v8, vcc
    buffer_store_dwordx4 v[204:207], v9, s[24:27], s31 offen sc1
    s_cmp_eq_u32 s28, 2
    s_cbranch_scc1 k0_kernel_tables
    s_branch k0_kernel_end
k0_kernel_wf:
    s_sub_u32 s34, s34, 12
    s_and_b32 s28, s33, 1
    s_mul_i32 s28, s28, 5
    s_lshr_b32 s30, s34, 2
    s_add_u32 s28, s28, s30
    s_lshr_b32 s29, s33, 1
    s_lshl_b32 s29, s29, 2
    s_and_b32 s30, s34, 3
    s_add_u32 s29, s29, s30
    s_mov_b32 s32, s8
    s_mov_b32 s33, s9
    s_mov_b32 s34, 819200
    s_mov_b32 s35, 0x20000
    s_mov_b32 s36, s12
    s_mov_b32 s37, s13
    s_mov_b32 s38, 819200
    s_mov_b32 s39, 0x20000
    s_mov_b32 s40, s14
    s_mov_b32 s41, s15
    s_mov_b32 s42, 819200
    s_mov_b32 s43, 0x20000
    s_lshl_b32 s54, s18, 2
    v_add_u32 v8, s54, v4
    v_xor_b32 v8, v8, v3
    v_lshlrev_b32 v8, 4, v8
    v_mul_u32_u24 v9, 1280, v4
    v_add_u32 v24, v8, v9
    v_lshrrev_b32 v9, 1, v4
    v_mul_u32_u24 v9, 10, v9
    v_and_b32 v10, 1, v4
    v_add_u32 v9, v9, v10
    v_mul_u32_u24 v9, 1280, v9
    v_add_u32 v25, v8, v9
    s_lshl_b32 s30, s28, 6
    s_add_u32 s30, s30, s54
    s_add_u32 s30, s30, 0
    s_mul_i32 s31, s30, 52429
    s_lshr_b32 s31, s31, 21
    s_mul_i32 s31, s31, 40
    s_sub_u32 s31, s30, s31
    s_sub_u32 s30, s30, s31
    s_lshr_b32 s55, s31, 3
    s_lshl_b32 s55, s55, 1
    s_add_u32 s55, s55, s31
    s_cmp_eq_u32 s31, 32
    s_cselect_b32 s55, 8, s55
    s_cmp_eq_u32 s31, 36
    s_cselect_b32 s55, 28, s55
    s_add_u32 s30, s30, s55
    s_cmp_ge_u32 s31, 32
    s_cselect_b64 s[52:53], -1, 0
    v_cndmask_b32 v26, v24, v25, s[52:53]
    s_mul_i32 s20, s30, 1280
    s_lshl_b32 s30, s28, 6
    s_add_u32 s30, s30, s54
    s_add_u32 s30, s30, 16
    s_mul_i32 s31, s30, 52429
    s_lshr_b32 s31, s31, 21
    s_mul_i32 s31, s31, 40
    s_sub_u32 s31, s30, s31
    s_sub_u32 s30, s30, s31
    s_lshr_b32 s55, s31, 3
    s_lshl_b32 s55, s55, 1
    s_add_u32 s55, s55, s31
    s_cmp_eq_u32 s31, 32
    s_cselect_b32 s55, 8, s55
    s_cmp_eq_u32 s31, 36
    s_cselect_b32 s55, 28, s55
    s_add_u32 s30, s30, s55
    s_cmp_ge_u32 s31, 32
    s_cselect_b64 s[52:53], -1, 0
    v_cndmask_b32 v27, v24, v25, s[52:53]
    s_mul_i32 s21, s30, 1280
    s_lshl_b32 s30, s28, 6
    s_add_u32 s30, s30, s54
    s_add_u32 s30, s30, 32
    s_mul_i32 s31, s30, 52429
    s_lshr_b32 s31, s31, 21
    s_mul_i32 s31, s31, 40
    s_sub_u32 s31, s30, s31
    s_sub_u32 s30, s30, s31
    s_lshr_b32 s55, s31, 3
    s_lshl_b32 s55, s55, 1
    s_add_u32 s55, s55, s31
    s_cmp_eq_u32 s31, 32
    s_cselect_b32 s55, 8, s55
    s_cmp_eq_u32 s31, 36
    s_cselect_b32 s55, 28, s55
    s_add_u32 s30, s30, s55
    s_cmp_ge_u32 s31, 32
    s_cselect_b64 s[52:53], -1, 0
    v_cndmask_b32 v28, v24, v25, s[52:53]
    s_mul_i32 s22, s30, 1280
    s_lshl_b32 s30, s28, 6
    s_add_u32 s30, s30, s54
    s_add_u32 s30, s30, 48
    s_mul_i32 s31, s30, 52429
    s_lshr_b32 s31, s31, 21
    s_mul_i32 s31, s31, 40
    s_sub_u32 s31, s30, s31
    s_sub_u32 s30, s30, s31
    s_lshr_b32 s55, s31, 3
    s_lshl_b32 s55, s55, 1
    s_add_u32 s55, s55, s31
    s_cmp_eq_u32 s31, 32
    s_cselect_b32 s55, 8, s55
    s_cmp_eq_u32 s31, 36
    s_cselect_b32 s55, 28, s55
    s_add_u32 s30, s30, s55
    s_cmp_ge_u32 s31, 32
    s_cselect_b64 s[52:53], -1, 0
    v_cndmask_b32 v29, v24, v25, s[52:53]
    s_mul_i32 s23, s30, 1280
    s_mul_i32 s55, s29, 20
    s_add_u32 s55, s55, 1
    s_add_u32 s30, s55, s54
    s_mul_i32 s60, s30, 1280
    s_add_u32 s30, s55, 16
    s_mul_i32 s30, s30, 1280
    s_mul_i32 s45, s18, 5120
    s_add_u32 s31, s45, 81920 + 40960
    s_add_u32 s56, s45, 81920 + 20480
    s_cmp_lt_u32 s18, 2
    s_cselect_b32 s61, s30, s60
    s_cselect_b32 s44, s31, s56
    s_cmp_eq_u32 s18, 0
    s_cselect_b32 s64, s36, s40
    s_cselect_b32 s65, s37, s41
    s_mov_b32 s66, 819200
    s_mov_b32 s67, 0x20000
    s_add_u32 s30, s20, 0
    s_add_u32 m0, s45, 0
    s_nop 0
    buffer_load_dwordx4 v26, s[32:35], s30 offen lds
    s_add_u32 s30, s21, 0
    s_add_u32 m0, s45, 20480
    s_nop 0
    buffer_load_dwordx4 v27, s[32:35], s30 offen lds
    s_add_u32 s30, s22, 0
    s_add_u32 m0, s45, 40960
    s_nop 0
    buffer_load_dwordx4 v28, s[32:35], s30 offen lds
    s_add_u32 s30, s23, 0
    s_add_u32 m0, s45, 61440
    s_nop 0
    buffer_load_dwordx4 v29, s[32:35], s30 offen lds
    s_add_u32 s30, s60, 0
    s_add_u32 m0, s45, 81920
    s_nop 0
    buffer_load_dwordx4 v24, s[36:39], s30 offen lds
    s_add_u32 s30, s60, 0
    s_add_u32 m0, s56, 0
    s_nop 0
    buffer_load_dwordx4 v24, s[40:43], s30 offen lds
    s_add_u32 s30, s61, 0
    s_add_u32 m0, s44, 0
    s_nop 0
    buffer_load_dwordx4 v24, s[64:67], s30 offen lds
    s_add_u32 s30, s20, 256
    s_add_u32 m0, s45, 1024
    s_nop 0
    buffer_load_dwordx4 v26, s[32:35], s30 offen lds
    s_add_u32 s30, s21, 256
    s_add_u32 m0, s45, 21504
    s_nop 0
    buffer_load_dwordx4 v27, s[32:35], s30 offen lds
    s_add_u32 s30, s22, 256
    s_add_u32 m0, s45, 41984
    s_nop 0
    buffer_load_dwordx4 v28, s[32:35], s30 offen lds
    s_add_u32 s30, s23, 256
    s_add_u32 m0, s45, 62464
    s_nop 0
    buffer_load_dwordx4 v29, s[32:35], s30 offen lds
    s_add_u32 s30, s60, 256
    s_add_u32 m0, s45, 82944
    s_nop 0
    buffer_load_dwordx4 v24, s[36:39], s30 offen lds
    s_add_u32 s30, s60, 256
    s_add_u32 m0, s56, 1024
    s_nop 0
    buffer_load_dwordx4 v24, s[40:43], s30 offen lds
    s_add_u32 s30, s61, 256
    s_add_u32 m0, s44, 1024
    s_nop 0
    buffer_load_dwordx4 v24, s[64:67], s30 offen lds
    s_add_u32 s30, s20, 512
    s_add_u32 m0, s45, 2048
    s_nop 0
    buffer_load_dwordx4 v26, s[32:35], s30 offen lds
    s_add_u32 s30, s21, 512
    s_add_u32 m0, s45, 22528
    s_nop 0
    buffer_load_dwordx4 v27, s[32:35], s30 offen lds
    s_add_u32 s30, s22, 512
    s_add_u32 m0, s45, 43008
    s_nop 0
    buffer_load_dwordx4 v28, s[32:35], s30 offen lds
    s_add_u32 s30, s23, 512
    s_add_u32 m0, s45, 63488
    s_nop 0
    buffer_load_dwordx4 v29, s[32:35], s30 offen lds
    s_add_u32 s30, s60, 512
    s_add_u32 m0, s45, 83968
    s_nop 0
    buffer_load_dwordx4 v24, s[36:39], s30 offen lds
    s_add_u32 s30, s60, 512
    s_add_u32 m0, s56, 2048
    s_nop 0
    buffer_load_dwordx4 v24, s[40:43], s30 offen lds
    s_add_u32 s30, s61, 512
    s_add_u32 m0, s44, 2048
    s_nop 0
    buffer_load_dwordx4 v24, s[64:67], s30 offen lds
    s_add_u32 s30, s20, 768
    s_add_u32 m0, s45, 3072
    s_nop 0
    buffer_load_dwordx4 v26, s[32:35], s30 offen lds
    s_add_u32 s30, s21, 768
    s_add_u32 m0, s45, 23552
    s_nop 0
    buffer_load_dwordx4 v27, s[32:35], s30 offen lds
    s_add_u32 s30, s22, 768
    s_add_u32 m0, s45, 44032
    s_nop 0
    buffer_load_dwordx4 v28, s[32:35], s30 offen lds
    s_add_u32 s30, s23, 768
    s_add_u32 m0, s45, 64512
    s_nop 0
    buffer_load_dwordx4 v29, s[32:35], s30 offen lds
    s_add_u32 s30, s60, 768
    s_add_u32 m0, s45, 84992
    s_nop 0
    buffer_load_dwordx4 v24, s[36:39], s30 offen lds
    s_add_u32 s30, s60, 768
    s_add_u32 m0, s56, 3072
    s_nop 0
    buffer_load_dwordx4 v24, s[40:43], s30 offen lds
    s_add_u32 s30, s61, 768
    s_add_u32 m0, s44, 3072
    s_nop 0
    buffer_load_dwordx4 v24, s[64:67], s30 offen lds
    s_add_u32 s30, s20, 1024
    s_add_u32 m0, s45, 4096
    s_nop 0
    buffer_load_dwordx4 v26, s[32:35], s30 offen lds
    s_add_u32 s30, s21, 1024
    s_add_u32 m0, s45, 24576
    s_nop 0
    buffer_load_dwordx4 v27, s[32:35], s30 offen lds
    s_add_u32 s30, s22, 1024
    s_add_u32 m0, s45, 45056
    s_nop 0
    buffer_load_dwordx4 v28, s[32:35], s30 offen lds
    s_add_u32 s30, s23, 1024
    s_add_u32 m0, s45, 65536
    s_nop 0
    buffer_load_dwordx4 v29, s[32:35], s30 offen lds
    s_add_u32 s30, s60, 1024
    s_add_u32 m0, s45, 86016
    s_nop 0
    buffer_load_dwordx4 v24, s[36:39], s30 offen lds
    s_add_u32 s30, s60, 1024
    s_add_u32 m0, s56, 4096
    s_nop 0
    buffer_load_dwordx4 v24, s[40:43], s30 offen lds
    s_add_u32 s30, s61, 1024
    s_add_u32 m0, s44, 4096
    s_nop 0
    buffer_load_dwordx4 v24, s[64:67], s30 offen lds
    v_lshrrev_b32 v21, 2, v3
    v_mul_u32_u24 v21, 5120, v21
    v_and_b32 v9, 3, v3
    v_lshl_add_u32 v21, v9, 8, v21
    s_mul_i32 s30, s18, 20480
    s_mov_b32 s31, 81920
    v_add_u32 v9, 0, v4
    v_xor_b32 v9, v9, v3
    v_lshlrev_b32 v9, 4, v9
    v_add3_u32 v184, v21, v9, s30
    v_add3_u32 v188, v21, v9, s31
    v_add_u32 v9, 4, v4
    v_xor_b32 v9, v9, v3
    v_lshlrev_b32 v9, 4, v9
    v_add3_u32 v185, v21, v9, s30
    v_add3_u32 v189, v21, v9, s31
    v_add_u32 v9, 8, v4
    v_xor_b32 v9, v9, v3
    v_lshlrev_b32 v9, 4, v9
    v_add3_u32 v186, v21, v9, s30
    v_add3_u32 v190, v21, v9, s31
    v_add_u32 v9, 12, v4
    v_xor_b32 v9, v9, v3
    v_lshlrev_b32 v9, 4, v9
    v_add3_u32 v187, v21, v9, s30
    v_add3_u32 v191, v21, v9, s31
    s_mul_i32 s31, s29, 5
    v_add_u32 v9, s31, v4
    v_lshrrev_b32 v10, 4, v9
    v_lshlrev_b32 v10, 10, v10
    v_and_b32 v9, 15, v9
    v_xor_b32 v9, v9, v3
    v_lshl_add_u32 v10, v9, 4, v10
    v_add3_u32 v15, v21, v10, s30
    v_add_u32 v9, s31, v4
    v_add_u32 v9, 4, v9
    v_lshrrev_b32 v10, 4, v9
    v_lshlrev_b32 v10, 10, v10
    v_and_b32 v9, 15, v9
    v_xor_b32 v9, v9, v3
    v_lshl_add_u32 v10, v9, 4, v10
    v_add3_u32 v16, v21, v10, s30
    v_mov_b32 v22, 0x3f80
    v_mov_b32 v23, 0x3f800000
    v_lshlrev_b32 v9, 3, v4
    v_sub_u32 v17, v3, v9
    v_add_u32 v18, 16, v17
    v_cmp_eq_u32 vcc, 0, v17
    s_nop 1
    v_cndmask_b32 v112, 0, v22, vcc
    v_cmp_eq_u32 vcc, 1, v17
    s_nop 1
    v_cndmask_b32 v112, v112, v23, vcc
    v_cmp_eq_u32 vcc, 2, v17
    s_nop 1
    v_cndmask_b32 v113, 0, v22, vcc
    v_cmp_eq_u32 vcc, 3, v17
    s_nop 1
    v_cndmask_b32 v113, v113, v23, vcc
    v_cmp_eq_u32 vcc, 4, v17
    s_nop 1
    v_cndmask_b32 v114, 0, v22, vcc
    v_cmp_eq_u32 vcc, 5, v17
    s_nop 1
    v_cndmask_b32 v114, v114, v23, vcc
    v_cmp_eq_u32 vcc, 6, v17
    s_nop 1
    v_cndmask_b32 v115, 0, v22, vcc
    v_cmp_eq_u32 vcc, 7, v17
    s_nop 1
    v_cndmask_b32 v115, v115, v23, vcc
    v_cmp_eq_u32 vcc, 0, v18
    s_nop 1
    v_cndmask_b32 v116, 0, v22, vcc
    v_cmp_eq_u32 vcc, 1, v18
    s_nop 1
    v_cndmask_b32 v116, v116, v23, vcc
    v_cmp_eq_u32 vcc, 2, v18
    s_nop 1
    v_cndmask_b32 v117, 0, v22, vcc
    v_cmp_eq_u32 vcc, 3, v18
    s_nop 1
    v_cndmask_b32 v117, v117, v23, vcc
    v_cmp_eq_u32 vcc, 4, v18
    s_nop 1
    v_cndmask_b32 v118, 0, v22, vcc
    v_cmp_eq_u32 vcc, 5, v18
    s_nop 1
    v_cndmask_b32 v118, v118, v23, vcc
    v_cmp_eq_u32 vcc, 6, v18
    s_nop 1
    v_cndmask_b32 v119, 0, v22, vcc
    v_cmp_eq_u32 vcc, 7, v18
    s_nop 1
    v_cndmask_b32 v119, v119, v23, vcc
    s_waitcnt vmcnt(28)
    s_barrier
    ds_read_b128 v[144:147], v184 offset:0
    ds_read_b128 v[148:151], v188 offset:0
    ds_read_b128 v[152:155], v188 offset:20480
    ds_read_b128 v[156:159], v188 offset:40960
    ds_read_b128 v[160:163], v185 offset:0
    ds_read_b128 v[164:167], v189 offset:0
    ds_read_b128 v[168:171], v189 offset:20480
    ds_read_b128 v[172:175], v189 offset:40960
    s_waitcnt lgkmcnt(4)
    v_mfma_f32_16x16x32_bf16 v[120:123], v[144:147], v[148:151], 0
    v_mfma_f32_16x16x32_bf16 v[124:127], v[144:147], v[152:155], 0
    v_mfma_f32_16x16x32_bf16 v[128:131], v[144:147], v[156:159], 0
    ds_read_b128 v[144:147], v186 offset:0
    ds_read_b128 v[148:151], v190 offset:0
    ds_read_b128 v[152:155], v190 offset:20480
    ds_read_b128 v[156:159], v190 offset:40960
    s_waitcnt lgkmcnt(4)
    v_mfma_f32_16x16x32_bf16 v[120:123], v[160:163], v[164:167], v[120:123]
    v_mfma_f32_16x16x32_bf16 v[124:127], v[160:163], v[168:171], v[124:127]
    v_mfma_f32_16x16x32_bf16 v[128:131], v[160:163], v[172:175], v[128:131]
    ds_read_b128 v[160:163], v187 offset:0
    ds_read_b128 v[164:167], v191 offset:0
    ds_read_b128 v[168:171], v191 offset:20480
    ds_read_b128 v[172:175], v191 offset:40960
    s_waitcnt lgkmcnt(4)
    v_mfma_f32_16x16x32_bf16 v[120:123], v[144:147], v[148:151], v[120:123]
    v_mfma_f32_16x16x32_bf16 v[124:127], v[144:147], v[152:155], v[124:127]
    v_mfma_f32_16x16x32_bf16 v[128:131], v[144:147], v[156:159], v[128:131]
    s_waitcnt vmcnt(21)
    s_barrier
    ds_read_b128 v[144:147], v184 offset:1024
    ds_read_b128 v[148:151], v188 offset:1024
    ds_read_b128 v[152:155], v188 offset:21504
    ds_read_b128 v[156:159], v188 offset:41984
    s_waitcnt lgkmcnt(4)
    v_mfma_f32_16x16x32_bf16 v[120:123], v[160:163], v[164:167], v[120:123]
    v_mfma_f32_16x16x32_bf16 v[124:127], v[160:163], v[168:171], v[124:127]
    v_mfma_f32_16x16x32_bf16 v[128:131], v[160:163], v[172:175], v[128:131]
    ds_read_b128 v[160:163], v185 offset:1024
    ds_read_b128 v[164:167], v189 offset:1024
    ds_read_b128 v[168:171], v189 offset:21504
    ds_read_b128 v[172:175], v189 offset:41984
    s_waitcnt lgkmcnt(4)
    v_mfma_f32_16x16x32_bf16 v[120:123], v[144:147], v[148:151], v[120:123]
    v_mfma_f32_16x16x32_bf16 v[124:127], v[144:147], v[152:155], v[124:127]
    v_mfma_f32_16x16x32_bf16 v[128:131], v[144:147], v[156:159], v[128:131]
    ds_read_b128 v[144:147], v186 offset:1024
    ds_read_b128 v[148:151], v190 offset:1024
    ds_read_b128 v[152:155], v190 offset:21504
    ds_read_b128 v[156:159], v190 offset:41984
    s_waitcnt lgkmcnt(4)
    v_mfma_f32_16x16x32_bf16 v[120:123], v[160:163], v[164:167], v[120:123]
    v_mfma_f32_16x16x32_bf16 v[124:127], v[160:163], v[168:171], v[124:127]
    v_mfma_f32_16x16x32_bf16 v[128:131], v[160:163], v[172:175], v[128:131]
    ds_read_b128 v[160:163], v187 offset:1024
    ds_read_b128 v[164:167], v191 offset:1024
    ds_read_b128 v[168:171], v191 offset:21504
    ds_read_b128 v[172:175], v191 offset:41984
    s_waitcnt lgkmcnt(4)
    v_mfma_f32_16x16x32_bf16 v[120:123], v[144:147], v[148:151], v[120:123]
    v_mfma_f32_16x16x32_bf16 v[124:127], v[144:147], v[152:155], v[124:127]
    v_mfma_f32_16x16x32_bf16 v[128:131], v[144:147], v[156:159], v[128:131]
    s_waitcnt vmcnt(14)
    s_barrier
    ds_read_b128 v[144:147], v184 offset:2048
    ds_read_b128 v[148:151], v188 offset:2048
    ds_read_b128 v[152:155], v188 offset:22528
    ds_read_b128 v[156:159], v188 offset:43008
    s_waitcnt lgkmcnt(4)
    v_mfma_f32_16x16x32_bf16 v[120:123], v[160:163], v[164:167], v[120:123]
    v_mfma_f32_16x16x32_bf16 v[124:127], v[160:163], v[168:171], v[124:127]
    v_mfma_f32_16x16x32_bf16 v[128:131], v[160:163], v[172:175], v[128:131]
    buffer_load_dwordx4 v[220:223], v212, s[48:51], s47 offen
    buffer_load_dwordx4 v[224:227], v213, s[48:51], s47 offen
    buffer_load_dwordx4 v[228:231], v214, s[48:51], s47 offen
    ds_read_b128 v[160:163], v185 offset:2048
    ds_read_b128 v[164:167], v189 offset:2048
    ds_read_b128 v[168:171], v189 offset:22528
    ds_read_b128 v[172:175], v189 offset:43008
    s_waitcnt lgkmcnt(4)
    v_mfma_f32_16x16x32_bf16 v[120:123], v[144:147], v[148:151], v[120:123]
    v_mfma_f32_16x16x32_bf16 v[124:127], v[144:147], v[152:155], v[124:127]
    v_mfma_f32_16x16x32_bf16 v[128:131], v[144:147], v[156:159], v[128:131]
    ds_read_b128 v[144:147], v186 offset:2048
    ds_read_b128 v[148:151], v190 offset:2048
    ds_read_b128 v[152:155], v190 offset:22528
    ds_read_b128 v[156:159], v190 offset:43008
    s_waitcnt lgkmcnt(4)
    v_mfma_f32_16x16x32_bf16 v[120:123], v[160:163], v[164:167], v[120:123]
    v_mfma_f32_16x16x32_bf16 v[124:127], v[160:163], v[168:171], v[124:127]
    v_mfma_f32_16x16x32_bf16 v[128:131], v[160:163], v[172:175], v[128:131]
    ds_read_b128 v[160:163], v187 offset:2048
    ds_read_b128 v[164:167], v191 offset:2048
    ds_read_b128 v[168:171], v191 offset:22528
    ds_read_b128 v[172:175], v191 offset:43008
    s_waitcnt lgkmcnt(4)
    v_mfma_f32_16x16x32_bf16 v[120:123], v[144:147], v[148:151], v[120:123]
    v_mfma_f32_16x16x32_bf16 v[124:127], v[144:147], v[152:155], v[124:127]
    v_mfma_f32_16x16x32_bf16 v[128:131], v[144:147], v[156:159], v[128:131]
    s_waitcnt vmcnt(10)
    s_barrier
    ds_read_b128 v[144:147], v184 offset:3072
    ds_read_b128 v[148:151], v188 offset:3072
    ds_read_b128 v[152:155], v188 offset:23552
    ds_read_b128 v[156:159], v188 offset:44032
    s_waitcnt lgkmcnt(4)
    v_mfma_f32_16x16x32_bf16 v[120:123], v[160:163], v[164:167], v[120:123]
    v_mfma_f32_16x16x32_bf16 v[124:127], v[160:163], v[168:171], v[124:127]
    v_mfma_f32_16x16x32_bf16 v[128:131], v[160:163], v[172:175], v[128:131]
    ds_read_b128 v[160:163], v185 offset:3072
    ds_read_b128 v[164:167], v189 offset:3072
    ds_read_b128 v[168:171], v189 offset:23552
    ds_read_b128 v[172:175], v189 offset:44032
    s_waitcnt lgkmcnt(4)
    v_mfma_f32_16x16x32_bf16 v[120:123], v[144:147], v[148:151], v[120:123]
    v_mfma_f32_16x16x32_bf16 v[124:127], v[144:147], v[152:155], v[124:127]
    v_mfma_f32_16x16x32_bf16 v[128:131], v[144:147], v[156:159], v[128:131]
    ds_read_b128 v[144:147], v186 offset:3072
    ds_read_b128 v[148:151], v190 offset:3072
    ds_read_b128 v[152:155], v190 offset:23552
    ds_read_b128 v[156:159], v190 offset:44032
    s_waitcnt lgkmcnt(4)
    v_mfma_f32_16x16x32_bf16 v[120:123], v[160:163], v[164:167], v[120:123]
    v_mfma_f32_16x16x32_bf16 v[124:127], v[160:163], v[168:171], v[124:127]
    v_mfma_f32_16x16x32_bf16 v[128:131], v[160:163], v[172:175], v[128:131]
    ds_read_b128 v[160:163], v187 offset:3072
    ds_read_b128 v[164:167], v191 offset:3072
    ds_read_b128 v[168:171], v191 offset:23552
    ds_read_b128 v[172:175], v191 offset:44032
    s_waitcnt lgkmcnt(4)
    v_mfma_f32_16x16x32_bf16 v[120:123], v[144:147], v[148:151], v[120:123]
    v_mfma_f32_16x16x32_bf16 v[124:127], v[144:147], v[152:155], v[124:127]
    v_mfma_f32_16x16x32_bf16 v[128:131], v[144:147], v[156:159], v[128:131]
    s_waitcnt vmcnt(3)
    s_barrier
    ds_read_b128 v[144:147], v184 offset:4096
    ds_read_b128 v[148:151], v188 offset:4096
    ds_read_b128 v[152:155], v188 offset:24576
    ds_read_b128 v[156:159], v188 offset:45056
    s_waitcnt lgkmcnt(4)
    v_mfma_f32_16x16x32_bf16 v[120:123], v[160:163], v[164:167], v[120:123]
    v_mfma_f32_16x16x32_bf16 v[124:127], v[160:163], v[168:171], v[124:127]
    v_mfma_f32_16x16x32_bf16 v[128:131], v[160:163], v[172:175], v[128:131]
    ds_read_b128 v[160:163], v185 offset:4096
    ds_read_b128 v[164:167], v189 offset:4096
    ds_read_b128 v[168:171], v189 offset:24576
    ds_read_b128 v[172:175], v189 offset:45056
    s_waitcnt lgkmcnt(4)
    v_mfma_f32_16x16x32_bf16 v[120:123], v[144:147], v[148:151], v[120:123]
    v_mfma_f32_16x16x32_bf16 v[124:127], v[144:147], v[152:155], v[124:127]
    v_mfma_f32_16x16x32_bf16 v[128:131], v[144:147], v[156:159], v[128:131]
    ds_read_b128 v[144:147], v186 offset:4096
    ds_read_b128 v[148:151], v190 offset:4096
    ds_read_b128 v[152:155], v190 offset:24576
    ds_read_b128 v[156:159], v190 offset:45056
    s_waitcnt lgkmcnt(4)
    v_mfma_f32_16x16x32_bf16 v[120:123], v[160:163], v[164:167], v[120:123]
    v_mfma_f32_16x16x32_bf16 v[124:127], v[160:163], v[168:171], v[124:127]
    v_mfma_f32_16x16x32_bf16 v[128:131], v[160:163], v[172:175], v[128:131]
    ds_read_b128 v[160:163], v187 offset:4096
    ds_read_b128 v[164:167], v191 offset:4096
    ds_read_b128 v[168:171], v191 offset:24576
    ds_read_b128 v[172:175], v191 offset:45056
    s_waitcnt lgkmcnt(4)
    v_mfma_f32_16x16x32_bf16 v[120:123], v[144:147], v[148:151], v[120:123]
    v_mfma_f32_16x16x32_bf16 v[124:127], v[144:147], v[152:155], v[124:127]
    v_mfma_f32_16x16x32_bf16 v[128:131], v[144:147], v[156:159], v[128:131]
    s_waitcnt lgkmcnt(0)
    v_mfma_f32_16x16x32_bf16 v[120:123], v[160:163], v[164:167], v[120:123]
    v_mfma_f32_16x16x32_bf16 v[124:127], v[160:163], v[168:171], v[124:127]
    v_mfma_f32_16x16x32_bf16 v[128:131], v[160:163], v[172:175], v[128:131]
    ds_read_b128 v[104:107], v15
    ds_read_b128 v[108:111], v16
    s_waitcnt lgkmcnt(0)
    v_mfma_f32_16x16x32_bf16 v[132:135], v[104:107], v[112:115], 0
    v_mfma_f32_16x16x32_bf16 v[136:139], v[104:107], v[116:119], 0
    v_mfma_f32_16x16x32_bf16 v[140:143], v[108:111], v[112:115], 0
    s_lshr_b32 s31, s18, 1
    s_mul_i32 s31, s31, 5120
    s_and_b32 s30, s18, 1
    s_lshl_b32 s30, s30, 9
    s_add_u32 s30, s30, s31
    s_add_u32 s30, s30, 143360
    v_lshrrev_b32 v8, 1, v4
    v_lshlrev_b32 v8, 8, v8
    v_and_b32 v9, 1, v4
    v_lshl_add_u32 v8, v9, 3, v8
    v_add_u32 v8, s30, v8
    v_mov_b32 v14, 153600
    v_cmp_le_u32 vcc, 10, v3
    s_nop 1
    v_cndmask_b32 v10, 10, 0, vcc
    v_add_u32 v10, v3, v10
    v_cndmask_b32 v11, 0, 4, vcc
    v_and_b32 v15, 3, v10
    v_add_u32 v11, v11, v15
    v_lshrrev_b32 v10, 2, v10
    v_lshlrev_b32 v10, 10, v10
    v_lshlrev_b32 v11, 4, v11
    v_add3_u32 v16, v8, v10, v11
    v_cmp_le_u32 vcc, 10, v3
    s_nop 1
    v_cndmask_b32 v10, 10, 0, vcc
    v_add_u32 v10, v3, v10
    v_cndmask_b32 v11, 0, 4, vcc
    v_and_b32 v15, 3, v10
    v_add_u32 v11, v11, v15
    v_add_u32 v11, 8, v11
    v_lshrrev_b32 v10, 2, v10
    v_lshlrev_b32 v10, 10, v10
    v_lshlrev_b32 v11, 4, v11
    v_add3_u32 v17, v8, v10, v11
    v_and_b32 v12, 3, v3
    v_add_u32 v12, 16, v12
    v_lshrrev_b32 v13, 2, v3
    v_cmp_le_u32 vcc, 10, v12
    s_nop 1
    v_cndmask_b32 v10, 10, 0, vcc
    v_add_u32 v10, v12, v10
    v_cndmask_b32 v11, 0, 4, vcc
    v_and_b32 v15, 3, v10
    v_add_u32 v11, v11, v15
    v_lshl_add_u32 v11, v13, 3, v11
    v_lshrrev_b32 v10, 2, v10
    v_lshlrev_b32 v10, 10, v10
    v_lshlrev_b32 v11, 4, v11
    v_add3_u32 v18, v8, v10, v11
    v_cmp_gt_u32 vcc, 8, v3
    s_nop 1
    v_cndmask_b32 v18, v14, v18, vcc
    v_lshrrev_b32 v13, 3, v3
    v_bfe_u32 v10, v3, 2, 1
    v_lshlrev_b32 v10, 10, v10
    v_and_b32 v11, 3, v3
    v_lshl_add_u32 v11, v13, 2, v11
    v_lshlrev_b32 v11, 4, v11
    v_add3_u32 v19, v8, v10, v11
    v_lshrrev_b32 v13, 3, v3
    v_add_u32 v13, 2, v13
    v_bfe_u32 v10, v3, 2, 1
    v_lshlrev_b32 v10, 10, v10
    v_and_b32 v11, 3, v3
    v_lshl_add_u32 v11, v13, 2, v11
    v_lshlrev_b32 v11, 4, v11
    v_add3_u32 v20, v8, v10, v11
    v_lshrrev_b32 v13, 1, v3
    v_mov_b32 v10, 2048
    v_and_b32 v11, 1, v3
    v_lshl_add_u32 v11, v13, 2, v11
    v_lshlrev_b32 v11, 4, v11
    v_add3_u32 v21, v8, v10, v11
    v_cmp_gt_u32 vcc, 8, v3
    s_nop 1
    v_cndmask_b32 v21, v14, v21, vcc
    v_cvt_pk_bf16_f32 v120, v120, v121
    v_cvt_pk_bf16_f32 v121, v122, v123
    ds_write_b64 v16, v[120:121]
    v_cvt_pk_bf16_f32 v124, v124, v125
    v_cvt_pk_bf16_f32 v125, v126, v127
    ds_write_b64 v17, v[124:125]
    v_cvt_pk_bf16_f32 v128, v128, v129
    v_cvt_pk_bf16_f32 v129, v130, v131
    ds_write_b64 v18, v[128:129]
    v_cvt_pk_bf16_f32 v132, v132, v133
    v_cvt_pk_bf16_f32 v133, v134, v135
    ds_write_b64 v19, v[132:133]
    v_cvt_pk_bf16_f32 v136, v136, v137
    v_cvt_pk_bf16_f32 v137, v138, v139
    ds_write_b64 v20, v[136:137]
    v_cvt_pk_bf16_f32 v140, v140, v141
    v_cvt_pk_bf16_f32 v141, v142, v143
    ds_write_b64 v21, v[140:141]
    s_waitcnt lgkmcnt(0)
    s_barrier
    v_lshlrev_b32 v8, 4, v0
    v_add_u32 v9, 143360, v8
    ds_read_b128 v[120:123], v9 offset:0
    ds_read_b128 v[124:127], v9 offset:4096
    ds_read_b128 v[128:131], v9 offset:8192
    s_waitcnt vmcnt(0)
    buffer_store_dwordx4 v[232:235], v219, s[24:27], s58 offen sc1
    v_subrev_u32 v216, 143360, v216
    ds_write_b128 v216, v[220:223]
    v_subrev_u32 v217, 143360, v217
    ds_write_b128 v217, v[224:227]
    v_subrev_u32 v218, 143360, v218
    v_cmp_gt_u32 vcc, 128, v0
    s_nop 0
    s_and_saveexec_b64 s[52:53], vcc
    ds_write_b128 v218, v[228:231]
    s_mov_b64 exec, s[52:53]
    s_mul_i32 s30, s29, 102400
    s_mul_i32 s31, s28, 10240
    s_add_u32 s30, s30, s31
    s_add_u32 s30, s30, 3276800
    v_mov_b32 v14, 1073741824
    v_cmp_gt_u32 vcc, 128, v0
    s_nop 1
    v_cndmask_b32 v9, v14, v8, vcc
    s_waitcnt lgkmcnt(2)
    buffer_store_dwordx4 v[120:123], v8, s[24:27], s30 offen sc1
    s_add_u32 s30, s30, 4096
    buffer_store_dwordx4 v[124:127], v8, s[24:27], s30 offen sc1
    s_add_u32 s30, s30, 4096
    buffer_store_dwordx4 v[128:131], v9, s[24:27], s30 offen sc1
    s_waitcnt lgkmcnt(0)
    s_barrier
    ds_read_b128 v[220:223], v8 offset:0
    ds_read_b128 v[224:227], v8 offset:4096
    ds_read_b128 v[228:231], v8 offset:8192
    s_waitcnt lgkmcnt(0)
    buffer_store_dwordx4 v[220:223], v8, s[24:27], s46 offen sc1
    s_add_u32 s46, s46, 4096
    buffer_store_dwordx4 v[224:227], v8, s[24:27], s46 offen sc1
    s_add_u32 s46, s46, 4096
    buffer_store_dwordx4 v[228:231], v9, s[24:27], s46 offen sc1
    s_branch k0_kernel_end
k0_kernel_tables:
    s_mov_b32 s28, s29
    s_cmp_gt_u32 s28, 4
    s_cbranch_scc1 k0_kernel_end
    v_lshlrev_b32 v9, 4, v1
    s_cmp_eq_u32 s28, 4
    s_cbranch_scc1 k0_kernel_tab2
    s_lshl_b32 s29, s28, 4
    v_add_u32 v8, s29, v3
    s_cmp_ge_u32 s18, 2
    s_cbranch_scc1 k0_kernel_tabtw
    s_lshl_b32 s29, s18, 5
    v_lshlrev_b32 v10, 3, v4
    v_add_u32 v10, s29, v10
    v_add_u32 v11, 0, v10
    v_mul_u32_u24 v11, v11, v8
    v_and_b32 v11, 63, v11
    v_cvt_f32_u32 v11, v11
    v_mul_f32 v11, 0.015625, v11
    v_cos_f32 v16, v11
    v_sin_f32 v24, v11
    v_add_u32 v11, 1, v10
    v_mul_u32_u24 v11, v11, v8
    v_and_b32 v11, 63, v11
    v_cvt_f32_u32 v11, v11
    v_mul_f32 v11, 0.015625, v11
    v_cos_f32 v17, v11
    v_sin_f32 v25, v11
    v_add_u32 v11, 2, v10
    v_mul_u32_u24 v11, v11, v8
    v_and_b32 v11, 63, v11
    v_cvt_f32_u32 v11, v11
    v_mul_f32 v11, 0.015625, v11
    v_cos_f32 v18, v11
    v_sin_f32 v26, v11
    v_add_u32 v11, 3, v10
    v_mul_u32_u24 v11, v11, v8
    v_and_b32 v11, 63, v11
    v_cvt_f32_u32 v11, v11
    v_mul_f32 v11, 0.015625, v11
    v_cos_f32 v19, v11
    v_sin_f32 v27, v11
    v_add_u32 v11, 4, v10
    v_mul_u32_u24 v11, v11, v8
    v_and_b32 v11, 63, v11
    v_cvt_f32_u32 v11, v11
    v_mul_f32 v11, 0.015625, v11
    v_cos_f32 v20, v11
    v_sin_f32 v28, v11
    v_add_u32 v11, 5, v10
    v_mul_u32_u24 v11, v11, v8
    v_and_b32 v11, 63, v11
    v_cvt_f32_u32 v11, v11
    v_mul_f32 v11, 0.015625, v11
    v_cos_f32 v21, v11
    v_sin_f32 v29, v11
    v_add_u32 v11, 6, v10
    v_mul_u32_u24 v11, v11, v8
    v_and_b32 v11, 63, v11
    v_cvt_f32_u32 v11, v11
    v_mul_f32 v11, 0.015625, v11
    v_cos_f32 v22, v11
    v_sin_f32 v30, v11
    v_add_u32 v11, 7, v10
    v_mul_u32_u24 v11, v11, v8
    v_and_b32 v11, 63, v11
    v_cvt_f32_u32 v11, v11
    v_mul_f32 v11, 0.015625, v11
    v_cos_f32 v23, v11
    v_sin_f32 v31, v11
    v_cvt_pk_bf16_f32 v32, v16, v17
    v_cvt_pk_bf16_f32 v40, v24, v25
    v_xor_b32 v36, 0x80008000, v40
    v_cvt_pk_bf16_f32 v33, v18, v19
    v_cvt_pk_bf16_f32 v41, v26, v27
    v_xor_b32 v37, 0x80008000, v41
    v_cvt_pk_bf16_f32 v34, v20, v21
    v_cvt_pk_bf16_f32 v42, v28, v29
    v_xor_b32 v38, 0x80008000, v42
    v_cvt_pk_bf16_f32 v35, v22, v23
    v_cvt_pk_bf16_f32 v43, v30, v31
    v_xor_b32 v39, 0x80008000, v43
    s_mul_i32 s29, s28, 6144
    s_lshl_b32 s30, s18, 10
    s_add_u32 s29, s29, s30
    s_add_u32 s29, s29, 4915200
    buffer_store_dwordx4 v[32:35], v9, s[24:27], s29 offen offset:0
    buffer_store_dwordx4 v[36:39], v9, s[24:27], s29 offen offset:2048
    s_add_u32 s29, s29, 4096
    buffer_store_dwordx4 v[40:43], v9, s[24:27], s29 offen offset:0
    s_branch k0_kernel_end
k0_kernel_tabtw:
    s_cmp_lg_u32 s18, 2
    s_cbranch_scc1 k0_kernel_end
    v_lshlrev_b32 v11, 2, v4
    v_add_u32 v11, 0, v11
    v_mul_u32_u24 v11, v11, v8
    v_cvt_f32_u32 v11, v11
    v_mul_f32 v11, 0.00048828125, v11
    v_cos_f32 v16, v11
    v_sin_f32 v24, v11
    v_lshlrev_b32 v11, 2, v4
    v_add_u32 v11, 1, v11
    v_mul_u32_u24 v11, v11, v8
    v_cvt_f32_u32 v11, v11
    v_mul_f32 v11, 0.00048828125, v11
    v_cos_f32 v17, v11
    v_sin_f32 v25, v11
    v_lshlrev_b32 v11, 2, v4
    v_add_u32 v11, 2, v11
    v_mul_u32_u24 v11, v11, v8
    v_cvt_f32_u32 v11, v11
    v_mul_f32 v11, 0.00048828125, v11
    v_cos_f32 v18, v11
    v_sin_f32 v26, v11
    v_lshlrev_b32 v11, 2, v4
    v_add_u32 v11, 3, v11
    v_mul_u32_u24 v11, v11, v8
    v_cvt_f32_u32 v11, v11
    v_mul_f32 v11, 0.00048828125, v11
    v_cos_f32 v19, v11
    v_sin_f32 v27, v11
    v_lshlrev_b32 v11, 2, v4
    v_add_u32 v11, 16, v11
    v_mul_u32_u24 v11, v11, v8
    v_cvt_f32_u32 v11, v11
    v_mul_f32 v11, 0.00048828125, v11
    v_cos_f32 v20, v11
    v_sin_f32 v28, v11
    v_lshlrev_b32 v11, 2, v4
    v_add_u32 v11, 17, v11
    v_mul_u32_u24 v11, v11, v8
    v_cvt_f32_u32 v11, v11
    v_mul_f32 v11, 0.00048828125, v11
    v_cos_f32 v21, v11
    v_sin_f32 v29, v11
    v_lshlrev_b32 v11, 2, v4
    v_add_u32 v11, 18, v11
    v_mul_u32_u24 v11, v11, v8
    v_cvt_f32_u32 v11, v11
    v_mul_f32 v11, 0.00048828125, v11
    v_cos_f32 v22, v11
    v_sin_f32 v30, v11
    v_lshlrev_b32 v11, 2, v4
    v_add_u32 v11, 19, v11
    v_mul_u32_u24 v11, v11, v8
    v_cvt_f32_u32 v11, v11
    v_mul_f32 v11, 0.00048828125, v11
    v_cos_f32 v23, v11
    v_sin_f32 v31, v11
    s_lshl_b32 s29, s28, 12
    s_add_u32 s29, s29, 4939776
    buffer_store_dwordx4 v[16:19], v9, s[24:27], s29 offen offset:0
    buffer_store_dwordx4 v[20:23], v9, s[24:27], s29 offen offset:1024
    buffer_store_dwordx4 v[24:27], v9, s[24:27], s29 offen offset:2048
    buffer_store_dwordx4 v[28:31], v9, s[24:27], s29 offen offset:3072
    s_branch k0_kernel_end
k0_kernel_tab2:
    s_cmp_ge_u32 s18, 2
    s_cbranch_scc1 k0_kernel_end
    s_lshl_b32 s29, s18, 4
    v_add_u32 v8, s29, v3
    v_lshlrev_b32 v11, 2, v4
    v_add_u32 v11, 0, v11
    v_mul_u32_u24 v11, v11, v8
    v_and_b32 v11, 31, v11
    v_cvt_f32_u32 v11, v11
    v_mul_f32 v11, 0.03125, v11
    v_cos_f32 v16, v11
    v_sin_f32 v24, v11
    v_lshlrev_b32 v11, 2, v4
    v_add_u32 v11, 1, v11
    v_mul_u32_u24 v11, v11, v8
    v_and_b32 v11, 31, v11
    v_cvt_f32_u32 v11, v11
    v_mul_f32 v11, 0.03125, v11
    v_cos_f32 v17, v11
    v_sin_f32 v25, v11
    v_lshlrev_b32 v11, 2, v4
    v_add_u32 v11, 2, v11
    v_mul_u32_u24 v11, v11, v8
    v_and_b32 v11, 31, v11
    v_cvt_f32_u32 v11, v11
    v_mul_f32 v11, 0.03125, v11
    v_cos_f32 v18, v11
    v_sin_f32 v26, v11
    v_lshlrev_b32 v11, 2, v4
    v_add_u32 v11, 3, v11
    v_mul_u32_u24 v11, v11, v8
    v_and_b32 v11, 31, v11
    v_cvt_f32_u32 v11, v11
    v_mul_f32 v11, 0.03125, v11
    v_cos_f32 v19, v11
    v_sin_f32 v27, v11
    v_lshlrev_b32 v11, 2, v4
    v_add_u32 v11, 16, v11
    v_mul_u32_u24 v11, v11, v8
    v_and_b32 v11, 31, v11
    v_cvt_f32_u32 v11, v11
    v_mul_f32 v11, 0.03125, v11
    v_cos_f32 v20, v11
    v_sin_f32 v28, v11
    v_lshlrev_b32 v11, 2, v4
    v_add_u32 v11, 17, v11
    v_mul_u32_u24 v11, v11, v8
    v_and_b32 v11, 31, v11
    v_cvt_f32_u32 v11, v11
    v_mul_f32 v11, 0.03125, v11
    v_cos_f32 v21, v11
    v_sin_f32 v29, v11
    v_lshlrev_b32 v11, 2, v4
    v_add_u32 v11, 18, v11
    v_mul_u32_u24 v11, v11, v8
    v_and_b32 v11, 31, v11
    v_cvt_f32_u32 v11, v11
    v_mul_f32 v11, 0.03125, v11
    v_cos_f32 v22, v11
    v_sin_f32 v30, v11
    v_lshlrev_b32 v11, 2, v4
    v_add_u32 v11, 19, v11
    v_mul_u32_u24 v11, v11, v8
    v_and_b32 v11, 31, v11
    v_cvt_f32_u32 v11, v11
    v_mul_f32 v11, 0.03125, v11
    v_cos_f32 v23, v11
    v_sin_f32 v31, v11
    v_cvt_pk_bf16_f32 v32, v16, v17
    v_cvt_pk_bf16_f32 v36, v24, v25
    v_cvt_pk_bf16_f32 v33, v18, v19
    v_cvt_pk_bf16_f32 v37, v26, v27
    v_cvt_pk_bf16_f32 v34, v20, v21
    v_cvt_pk_bf16_f32 v38, v28, v29
    v_cvt_pk_bf16_f32 v35, v22, v23
    v_cvt_pk_bf16_f32 v39, v30, v31
    s_lshl_b32 s29, s18, 11
    s_add_u32 s29, s29, 4956160
    buffer_store_dwordx4 v[32:35], v9, s[24:27], s29 offen
    buffer_store_dwordx4 v[36:39], v9, s[24:27], s29 offen offset:1024
k0_kernel_end:
k0_kernel_exit:
    s_endpgm
.text
.globl kAl1_kernel
.p2align 8
.type kAl1_kernel,@function
kAl1_kernel:
    s_mov_b32 s32, 11567104
    s_branch kA_body
.text
.globl kAl0_kernel
.p2align 8
.type kAl0_kernel,@function
kAl0_kernel:
    s_mov_b32 s32, 0
    s_nop 0
kA_body:
    s_cmp_ge_u32 s2, 256
    s_cbranch_scc1 kA_end
    s_load_dwordx2 s[30:31], s[0:1], 88
    s_and_b32 s19, s2, 7
    s_lshr_b32 s20, s2, 3
    s_lshr_b32 s16, s19, 1
    s_lshl_b32 s16, s16, 2
    s_and_b32 s17, s20, 3
    s_add_u32 s16, s16, s17
    s_and_b32 s17, s19, 1
    s_lshl_b32 s17, s17, 3
    s_lshr_b32 s20, s20, 2
    s_add_u32 s17, s17, s20
    v_and_b32 v1, 63, v0
    v_lshrrev_b32 v2, 6, v0
    s_nop 0
    v_readfirstlane_b32 s18, v2
    v_lshlrev_b32 v5, 4, v1
    s_lshl_b32 s44, s16, 2
    s_add_u32 s44, s44, s18
    s_mul_i32 s44, s44, 40960
    s_add_u32 s19, s44, 13926400
    s_mul_i32 s34, s17, 204800
    s_lshl_b32 s21, s18, 10
    s_mul_i32 s64, s18, 3072
    s_lshl_b32 s65, s18, 11
    s_mov_b32 s20, 0
    s_mov_b32 s35, 20480
    s_mov_b32 s6, 40960
    s_mov_b32 s7, 0x20000
    s_mov_b32 s10, 163840
    s_mov_b32 s11, 0x20000
    s_add_u32 s19, s19, s32
    s_waitcnt lgkmcnt(0)
    s_add_u32 s4, s30, s19
    s_addc_u32 s5, s31, 0
    s_add_u32 s8, s30, s34
    s_addc_u32 s9, s31, 0
    s_add_u32 m0, s64, 0
    s_nop 0
    buffer_load_dwordx4 v5, s[8:11], m0 offen lds
    s_add_u32 m0, s64, 1024
    s_nop 0
    buffer_load_dwordx4 v5, s[8:11], m0 offen lds
    s_add_u32 m0, s64, 2048
    s_nop 0
    buffer_load_dwordx4 v5, s[8:11], m0 offen lds
    buffer_load_dwordx4 a[0:3], v5, s[4:7], s20 offen offset:0
    v_and_b32 v2, 15, v1
    v_lshrrev_b32 v3, 4, v1
    v_add_u32 v6, 61440, v5
    v_add_u32 v7, 102400, v5
    s_add_u32 s36, s8, 102400
    s_addc_u32 s37, s9, 0
    s_mov_b32 s38, 102400
    s_mov_b32 s39, 0x20000
    s_add_u32 s12, s30, s32
    s_addc_u32 s13, s31, 0
    buffer_load_dwordx4 a[4:7], v5, s[4:7], s35 offen offset:0
    s_sub_u32 s14, 28114944, s32
    s_mov_b32 s15, 0x20000
    s_mul_i32 s34, s17, 102400
    s_add_u32 s34, s34, 3174400
    s_add_u32 s48, s30, s34
    s_addc_u32 s49, s31, 0
    s_mov_b32 s50, 163840
    s_mov_b32 s51, 0x20000
    s_add_u32 s52, s48, 102400
    s_addc_u32 s53, s49, 0
    buffer_load_dwordx4 a[8:11], v5, s[4:7], s20 offen offset:1024
    s_mov_b32 s54, 102400
    s_mov_b32 s55, 0x20000
    v_and_b32 v8, 1, v3
    v_lshrrev_b32 v12, 1, v3
    v_lshlrev_b32 v236, 4, v2
    v_lshl_add_u32 v238, v12, 3, v236
    v_lshl_add_u32 v236, v3, 8, v236
    v_add_u32 v237, 20480, v236
    buffer_load_dwordx4 a[12:15], v5, s[4:7], s35 offen offset:1024
    v_mul_u32_u24 v9, 20480, v8
    v_add_u32 v238, v238, v9
    v_add_u32 v238, 1024, v238
    s_mul_i32 s46, s17, 1280
    s_add_u32 s46, s46, s44
    s_lshl_b32 s19, s18, 5
    v_add_u32 v9, s19, v2
    v_mul_u32_u24 v9, 352, v9
    s_add_u32 m0, s64, 12288
    s_nop 0
    buffer_load_dwordx4 v5, s[8:11], m0 offen lds
    v_mul_u32_u24 v10, 48, v3
    v_add_u32 v244, v9, v10
    v_lshl_add_u32 v245, v3, 5, v9
    v_add_u32 v245, 192, v245
    v_lshrrev_b32 v9, 2, v2
    v_lshl_add_u32 v9, v3, 2, v9
    v_mul_u32_u24 v9, 352, v9
    v_and_b32 v10, 3, v1
    s_add_u32 m0, s64, 13312
    s_nop 0
    buffer_load_dwordx4 v5, s[8:11], m0 offen lds
    v_lshl_add_u32 v9, v10, 3, v9
    s_lshr_b32 s19, s18, 1
    s_and_b32 s23, s18, 1
    s_mul_i32 s3, s19, 96
    v_add_u32 v246, s3, v9
    s_lshl_b32 s3, s18, 5
    s_add_u32 s3, s3, 192
    v_add_u32 v247, s3, v9
    s_add_u32 m0, s64, 14336
    s_nop 0
    buffer_load_dwordx4 v5, s[8:11], m0 offen lds
    s_mul_i32 s3, s23, 10
    v_add_u32 v9, s3, v2
    v_cmp_eq_u32 vcc, 10, v2
    v_mov_b32 v10, 20
    s_nop 0
    v_cndmask_b32 v9, v9, v10, vcc
    v_mul_u32_u24 v9, 96, v9
    v_lshl_add_u32 v9, v3, 3, v9
    s_mul_i32 s3, s19, 2016
    buffer_load_dwordx4 a[16:19], v5, s[4:7], s20 offen offset:2048
    s_add_u32 s3, s3, 51200
    v_add_u32 v9, s3, v9
    s_sub_u32 s3, 11, s23
    v_mov_b32 v11, 55296
    v_cmp_gt_u32 vcc, s3, v2
    s_nop 1
    v_cndmask_b32 v248, v11, v9, vcc
    v_lshlrev_b32 v9, 4, v0
    v_add_u32 v251, 51200, v9
    buffer_load_dwordx4 a[20:23], v5, s[4:7], s35 offen offset:2048
    v_add_u32 v252, 45056, v9
    v_mov_b32 v11, 1073741824
    v_cmp_gt_u32 vcc, 252, v0
    s_nop 1
    v_cndmask_b32 v250, v11, v9, vcc
    s_lshl_b32 s3, s17, 4
    s_mul_i32 s61, s3, 4096
    s_add_u32 s61, s61, 5013504
    s_mul_i32 s56, s16, 4096
    buffer_load_dwordx4 a[24:27], v5, s[4:7], s20 offen offset:3072
    s_add_u32 s56, s56, s61
    v_and_b32 v13, 3, v2
    v_bfe_u32 v10, v2, 2, 1
    v_mul_u32_u24 v10, 10, v10
    v_add_u32 v10, v10, v13
    v_mul_u32_u24 v11, 2016, v12
    v_mul_u32_u24 v14, 48, v8
    v_add_u32 v11, v11, v14
    buffer_load_dwordx4 a[28:31], v5, s[4:7], s35 offen offset:3072
    v_add_u32 v11, 45056, v11
    v_mul_u32_u24 v14, 96, v10
    v_add_u32 v14, v14, v11
    v_lshrrev_b32 v15, 3, v2
    v_cmp_eq_u32 s[40:41], v15, v12
    v_mov_b32 v15, 49152
    s_nop 0
    v_cndmask_b32 v253, v15, v14, s[40:41]
    v_add_u32 v10, 8, v10
    s_add_u32 s20, s20, 4096
    s_add_u32 s35, s35, 4096
    buffer_load_dwordx4 a[32:35], v5, s[4:7], s20 offen offset:0
    v_cmp_eq_u32 vcc, 2, v13
    v_mov_b32 v14, 20
    s_nop 0
    v_cndmask_b32 v10, v10, v14, vcc
    v_mul_u32_u24 v14, 96, v10
    v_add_u32 v14, v14, v11
    v_cndmask_b32 v14, v15, v14, s[40:41]
    v_cmp_eq_u32 vcc, 3, v13
    s_nop 1
    v_cndmask_b32 v249, v14, v15, vcc
    buffer_load_dwordx4 a[36:39], v5, s[4:7], s35 offen offset:0
    v_mul_u32_u24 v10, 5472, v8
    v_mul_u32_u24 v11, 272, v12
    v_add_u32 v10, v10, v11
    v_lshrrev_b32 v11, 2, v2
    v_lshl_add_u32 v10, v11, 6, v10
    v_lshl_add_u32 v10, v13, 2, v10
    s_lshl_b32 s3, s18, 4
    v_add_u32 v254, s3, v10
    buffer_load_dwordx4 a[40:43], v5, s[4:7], s20 offen offset:1024
    v_lshrrev_b32 v10, 4, v0
    v_lshl_add_u32 v239, v10, 4, v9
    v_lshrrev_b32 v10, 4, v0
    v_lshlrev_b32 v10, 12, v10
    v_bfe_u32 v11, v0, 2, 2
    v_lshl_add_u32 v10, v11, 8, v10
    v_and_b32 v11, 3, v0
    v_lshl_add_u32 v255, v11, 4, v10
    buffer_load_dwordx4 a[44:47], v5, s[4:7], s35 offen offset:1024
    v_mov_b32 v11, 1073741824
    v_cmp_gt_u32 vcc, 128, v0
    s_nop 1
    v_cndmask_b32 v243, v11, v255, vcc
    s_lshr_b32 s19, s16, 1
    s_lshr_b32 s60, s19, 2
    s_lshl_b32 s60, s60, 11
    s_and_b32 s3, s19, 3
    s_lshl_b32 s3, s3, 6
    s_add_u32 m0, s64, 24576
    s_nop 0
    buffer_load_dwordx4 v5, s[8:11], m0 offen lds
    s_add_u32 s60, s60, s3
    s_and_b32 s23, s16, 1
    s_lshl_b32 s3, s23, 10
    s_add_u32 s60, s60, s3
    s_mul_i32 s3, s17, 163840
    s_add_u32 s60, s60, s3
    s_add_u32 s60, s60, 11304960
    s_lshl_b32 s19, s19, 2
    s_add_u32 m0, s64, 25600
    s_nop 0
    buffer_load_dwordx4 v5, s[8:11], m0 offen lds
    s_add_u32 s19, s19, s18
    s_lshl_b32 s59, s19, 6
    s_lshl_b32 s3, s23, 5
    s_add_u32 s59, s59, s3
    s_lshl_b32 s59, s59, 2
    s_add_u32 s59, s59, 4980736
    v_lshl_add_u32 v10, v2, 1, v12
    v_lshlrev_b32 v10, 2, v10
    s_add_u32 m0, s64, 26624
    s_nop 0
    buffer_load_dwordx4 v5, s[8:11], m0 offen lds
    v_mov_b32 v11, 1073741824
    v_cmp_eq_u32 vcc, 0, v8
    s_nop 1
    v_cndmask_b32 v242, v11, v10, vcc
    v_mov_b32 v152, 0x3f803f80
    v_mov_b32 v153, 0x3f803f80
    v_mov_b32 v154, 0x3f803f80
    v_mov_b32 v155, 0x3f803f80
    v_cmp_eq_u32 s[24:25], 1, v13
    buffer_load_dwordx4 a[48:51], v5, s[4:7], s20 offen offset:2048
    v_cmp_eq_u32 s[28:29], 3, v13
    v_lshrrev_b32 v9, 2, v2
    v_lshl_add_u32 v9, v9, 4, v2
    v_lshlrev_b32 v9, 2, v9
    v_and_b32 v8, 2, v2
    v_cmp_eq_u32 s[22:23], 2, v8
    s_lshl_b32 s45, s17, 7
    s_add_u32 s45, s45, 4997120
    s_waitcnt vmcnt(19)
    s_barrier
    ds_read_b128 v[16:19], v5 offset:0
    ds_read_b128 v[20:23], v5 offset:1024
    ds_read_b128 v[24:27], v5 offset:2048
    ds_read_b128 v[28:31], v5 offset:3072
    ds_read_b128 v[32:35], v5 offset:4096
    ds_read_b128 v[36:39], v5 offset:5120
    s_waitcnt lgkmcnt(3)
    s_waitcnt vmcnt(17)
    v_mfma_f32_16x16x32_bf16 v[56:59], v[16:19], a[0:3], 0
    ds_read_b128 v[40:43], v5 offset:6144
    buffer_load_dwordx4 a[52:55], v5, s[4:7], s35 offen offset:2048
    v_mfma_f32_16x16x32_bf16 v[76:79], v[16:19], a[4:7], 0
    ds_read_b128 v[44:47], v5 offset:7168
    v_mfma_f32_16x16x32_bf16 v[60:63], v[20:23], a[0:3], 0
    ds_read_b128 v[48:51], v5 offset:8192
    v_mfma_f32_16x16x32_bf16 v[80:83], v[20:23], a[4:7], 0
    v_mfma_f32_16x16x32_bf16 v[64:67], v[24:27], a[0:3], 0
    buffer_load_dwordx4 a[56:59], v5, s[4:7], s20 offen offset:3072
    v_mfma_f32_16x16x32_bf16 v[84:87], v[24:27], a[4:7], 0
    v_mfma_f32_16x16x32_bf16 v[136:139], v[152:155], a[0:3], 0
    v_mfma_f32_16x16x32_bf16 v[144:147], a[0:3], a[0:3], 0
    v_mfma_f32_16x16x32_bf16 v[140:143], v[152:155], a[4:7], 0
    buffer_load_dwordx4 a[60:63], v5, s[4:7], s35 offen offset:3072
    s_add_u32 s20, s20, 4096
    v_mfma_f32_16x16x32_bf16 v[148:151], a[4:7], a[4:7], 0
    s_add_u32 s35, s35, 4096
    s_waitcnt lgkmcnt(3)
    s_waitcnt vmcnt(18)
    v_mfma_f32_16x16x32_bf16 v[56:59], v[28:31], a[8:11], v[56:59]
    ds_read_b128 v[16:19], v5 offset:9216
    v_mfma_f32_16x16x32_bf16 v[76:79], v[28:31], a[12:15], v[76:79]
    ds_read_b128 v[20:23], v5 offset:10240
    v_mfma_f32_16x16x32_bf16 v[60:63], v[32:35], a[8:11], v[60:63]
    ds_read_b128 v[24:27], v5 offset:11264
    buffer_load_dwordx4 a[64:67], v5, s[4:7], s20 offen offset:0
    v_mfma_f32_16x16x32_bf16 v[80:83], v[32:35], a[12:15], v[80:83]
    v_mfma_f32_16x16x32_bf16 v[64:67], v[36:39], a[8:11], v[64:67]
    v_mfma_f32_16x16x32_bf16 v[84:87], v[36:39], a[12:15], v[84:87]
    v_mfma_f32_16x16x32_bf16 v[136:139], v[152:155], a[8:11], v[136:139]
    buffer_load_dwordx4 a[68:71], v5, s[4:7], s35 offen offset:0
    v_mfma_f32_16x16x32_bf16 v[144:147], a[8:11], a[8:11], v[144:147]
    v_mfma_f32_16x16x32_bf16 v[140:143], v[152:155], a[12:15], v[140:143]
    v_mfma_f32_16x16x32_bf16 v[148:151], a[12:15], a[12:15], v[148:151]
    s_waitcnt lgkmcnt(3)
    s_waitcnt vmcnt(15)
    s_barrier
    v_mfma_f32_16x16x32_bf16 v[56:59], v[40:43], a[16:19], v[56:59]
    ds_read_b128 v[28:31], v5 offset:12288
    buffer_load_dwordx4 a[72:75], v5, s[4:7], s20 offen offset:1024
    v_mfma_f32_16x16x32_bf16 v[76:79], v[40:43], a[20:23], v[76:79]
    ds_read_b128 v[32:35], v5 offset:13312
    v_mfma_f32_16x16x32_bf16 v[60:63], v[44:47], a[16:19], v[60:63]
    ds_read_b128 v[36:39], v5 offset:14336
    v_mfma_f32_16x16x32_bf16 v[80:83], v[44:47], a[20:23], v[80:83]
    v_mfma_f32_16x16x32_bf16 v[64:67], v[48:51], a[16:19], v[64:67]
    buffer_load_dwordx4 a[76:79], v5, s[4:7], s35 offen offset:1024
    s_add_u32 m0, s64, 36864
    v_mfma_f32_16x16x32_bf16 v[84:87], v[48:51], a[20:23], v[84:87]
    v_mfma_f32_16x16x32_bf16 v[136:139], v[152:155], a[16:19], v[136:139]
    v_mfma_f32_16x16x32_bf16 v[144:147], a[16:19], a[16:19], v[144:147]
    v_mfma_f32_16x16x32_bf16 v[140:143], v[152:155], a[20:23], v[140:143]
    buffer_load_dwordx4 v5, s[8:11], m0 offen lds
    s_add_u32 m0, s64, 37888
    v_mfma_f32_16x16x32_bf16 v[148:151], a[20:23], a[20:23], v[148:151]
    s_waitcnt lgkmcnt(3)
    s_waitcnt vmcnt(16)
    v_mfma_f32_16x16x32_bf16 v[56:59], v[16:19], a[24:27], v[56:59]
    ds_read_b128 v[40:43], v5 offset:15360
    v_mfma_f32_16x16x32_bf16 v[76:79], v[16:19], a[28:31], v[76:79]
    ds_read_b128 v[44:47], v5 offset:16384
    v_mfma_f32_16x16x32_bf16 v[60:63], v[20:23], a[24:27], v[60:63]
    ds_read_b128 v[48:51], v5 offset:17408
    buffer_load_dwordx4 v5, s[8:11], m0 offen lds
    v_mfma_f32_16x16x32_bf16 v[80:83], v[20:23], a[28:31], v[80:83]
    s_add_u32 m0, s64, 38912
    v_mfma_f32_16x16x32_bf16 v[64:67], v[24:27], a[24:27], v[64:67]
    v_mfma_f32_16x16x32_bf16 v[84:87], v[24:27], a[28:31], v[84:87]
    v_mfma_f32_16x16x32_bf16 v[136:139], v[152:155], a[24:27], v[136:139]
    buffer_load_dwordx4 v5, s[8:11], m0 offen lds
    v_mfma_f32_16x16x32_bf16 v[144:147], a[24:27], a[24:27], v[144:147]
    v_mfma_f32_16x16x32_bf16 v[140:143], v[152:155], a[28:31], v[140:143]
    v_mfma_f32_16x16x32_bf16 v[148:151], a[28:31], a[28:31], v[148:151]
    s_waitcnt lgkmcnt(3)
    s_waitcnt vmcnt(16)
    v_mfma_f32_16x16x32_bf16 v[56:59], v[28:31], a[32:35], v[56:59]
    ds_read_b128 v[16:19], v5 offset:18432
    buffer_load_dwordx4 a[80:83], v5, s[4:7], s20 offen offset:2048
    v_mfma_f32_16x16x32_bf16 v[76:79], v[28:31], a[36:39], v[76:79]
    ds_read_b128 v[20:23], v5 offset:19456
    v_mfma_f32_16x16x32_bf16 v[60:63], v[32:35], a[32:35], v[60:63]
    ds_read_b128 v[24:27], v5 offset:20480
    v_mfma_f32_16x16x32_bf16 v[80:83], v[32:35], a[36:39], v[80:83]
    v_mfma_f32_16x16x32_bf16 v[64:67], v[36:39], a[32:35], v[64:67]
    buffer_load_dwordx4 a[84:87], v5, s[4:7], s35 offen offset:2048
    v_mfma_f32_16x16x32_bf16 v[84:87], v[36:39], a[36:39], v[84:87]
    v_mfma_f32_16x16x32_bf16 v[136:139], v[152:155], a[32:35], v[136:139]
    v_mfma_f32_16x16x32_bf16 v[144:147], a[32:35], a[32:35], v[144:147]
    v_mfma_f32_16x16x32_bf16 v[140:143], v[152:155], a[36:39], v[140:143]
    buffer_load_dwordx4 a[88:91], v5, s[4:7], s20 offen offset:3072
    v_mfma_f32_16x16x32_bf16 v[148:151], a[36:39], a[36:39], v[148:151]
    s_waitcnt lgkmcnt(3)
    s_waitcnt vmcnt(17)
    v_mfma_f32_16x16x32_bf16 v[56:59], v[40:43], a[40:43], v[56:59]
    ds_read_b128 v[28:31], v5 offset:21504
    v_mfma_f32_16x16x32_bf16 v[76:79], v[40:43], a[44:47], v[76:79]
    ds_read_b128 v[32:35], v5 offset:22528
    v_mfma_f32_16x16x32_bf16 v[60:63], v[44:47], a[40:43], v[60:63]
    ds_read_b128 v[36:39], v5 offset:23552
    buffer_load_dwordx4 a[92:95], v5, s[4:7], s35 offen offset:3072
    v_mfma_f32_16x16x32_bf16 v[80:83], v[44:47], a[44:47], v[80:83]
    s_add_u32 s20, s20, 4096
    s_add_u32 s35, s35, 4096
    v_mfma_f32_16x16x32_bf16 v[64:67], v[48:51], a[40:43], v[64:67]
    v_mfma_f32_16x16x32_bf16 v[84:87], v[48:51], a[44:47], v[84:87]
    v_mfma_f32_16x16x32_bf16 v[136:139], v[152:155], a[40:43], v[136:139]
    buffer_load_dwordx4 a[96:99], v5, s[4:7], s20 offen offset:0
    v_mfma_f32_16x16x32_bf16 v[144:147], a[40:43], a[40:43], v[144:147]
    v_mfma_f32_16x16x32_bf16 v[140:143], v[152:155], a[44:47], v[140:143]
    v_mfma_f32_16x16x32_bf16 v[148:151], a[44:47], a[44:47], v[148:151]
    s_waitcnt lgkmcnt(3)
    s_waitcnt vmcnt(14)
    s_barrier
    v_mfma_f32_16x16x32_bf16 v[56:59], v[16:19], a[48:51], v[56:59]
    ds_read_b128 v[40:43], v5 offset:24576
    buffer_load_dwordx4 a[100:103], v5, s[4:7], s35 offen offset:0
    v_mfma_f32_16x16x32_bf16 v[76:79], v[16:19], a[52:55], v[76:79]
    ds_read_b128 v[44:47], v5 offset:25600
    v_mfma_f32_16x16x32_bf16 v[60:63], v[20:23], a[48:51], v[60:63]
    ds_read_b128 v[48:51], v5 offset:26624
    v_mfma_f32_16x16x32_bf16 v[80:83], v[20:23], a[52:55], v[80:83]
    v_mfma_f32_16x16x32_bf16 v[64:67], v[24:27], a[48:51], v[64:67]
    buffer_load_dwordx4 a[104:107], v5, s[4:7], s20 offen offset:1024
    v_mfma_f32_16x16x32_bf16 v[84:87], v[24:27], a[52:55], v[84:87]
    v_mfma_f32_16x16x32_bf16 v[136:139], v[152:155], a[48:51], v[136:139]
    v_mfma_f32_16x16x32_bf16 v[144:147], a[48:51], a[48:51], v[144:147]
    v_mfma_f32_16x16x32_bf16 v[140:143], v[152:155], a[52:55], v[140:143]
    buffer_load_dwordx4 a[108:111], v5, s[4:7], s35 offen offset:1024
    s_add_u32 m0, s64, 49152
    v_mfma_f32_16x16x32_bf16 v[148:151], a[52:55], a[52:55], v[148:151]
    s_waitcnt lgkmcnt(3)
    s_waitcnt vmcnt(15)
    v_mfma_f32_16x16x32_bf16 v[56:59], v[28:31], a[56:59], v[56:59]
    ds_read_b128 v[16:19], v5 offset:27648
    v_mfma_f32_16x16x32_bf16 v[76:79], v[28:31], a[60:63], v[76:79]
    ds_read_b128 v[20:23], v5 offset:28672
    v_mfma_f32_16x16x32_bf16 v[60:63], v[32:35], a[56:59], v[60:63]
    ds_read_b128 v[24:27], v5 offset:29696
    buffer_load_dwordx4 v5, s[8:11], m0 offen lds
    v_mfma_f32_16x16x32_bf16 v[80:83], v[32:35], a[60:63], v[80:83]
    s_add_u32 m0, s64, 50176
    v_mfma_f32_16x16x32_bf16 v[64:67], v[36:39], a[56:59], v[64:67]
    v_mfma_f32_16x16x32_bf16 v[84:87], v[36:39], a[60:63], v[84:87]
    v_mfma_f32_16x16x32_bf16 v[136:139], v[152:155], a[56:59], v[136:139]
    buffer_load_dwordx4 v5, s[8:11], m0 offen lds
    s_add_u32 m0, s64, 51200
    v_mfma_f32_16x16x32_bf16 v[144:147], a[56:59], a[56:59], v[144:147]
    v_mfma_f32_16x16x32_bf16 v[140:143], v[152:155], a[60:63], v[140:143]
    v_mfma_f32_16x16x32_bf16 v[148:151], a[60:63], a[60:63], v[148:151]
    s_waitcnt lgkmcnt(3)
    s_waitcnt vmcnt(15)
    v_mfma_f32_16x16x32_bf16 v[56:59], v[40:43], a[64:67], v[56:59]
    ds_read_b128 v[28:31], v5 offset:30720
    buffer_load_dwordx4 v5, s[8:11], m0 offen lds
    v_mfma_f32_16x16x32_bf16 v[76:79], v[40:43], a[68:71], v[76:79]
    ds_read_b128 v[32:35], v5 offset:31744
    v_mfma_f32_16x16x32_bf16 v[60:63], v[44:47], a[64:67], v[60:63]
    ds_read_b128 v[36:39], v5 offset:32768
    v_mfma_f32_16x16x32_bf16 v[80:83], v[44:47], a[68:71], v[80:83]
    v_mfma_f32_16x16x32_bf16 v[64:67], v[48:51], a[64:67], v[64:67]
    buffer_load_dwordx4 a[112:115], v5, s[4:7], s20 offen offset:2048
    v_mfma_f32_16x16x32_bf16 v[84:87], v[48:51], a[68:71], v[84:87]
    v_mfma_f32_16x16x32_bf16 v[136:139], v[152:155], a[64:67], v[136:139]
    v_mfma_f32_16x16x32_bf16 v[144:147], a[64:67], a[64:67], v[144:147]
    v_mfma_f32_16x16x32_bf16 v[140:143], v[152:155], a[68:71], v[140:143]
    buffer_load_dwordx4 a[116:119], v5, s[4:7], s35 offen offset:2048
    v_mfma_f32_16x16x32_bf16 v[148:151], a[68:71], a[68:71], v[148:151]
    s_waitcnt lgkmcnt(3)
    s_waitcnt vmcnt(16)
    v_mfma_f32_16x16x32_bf16 v[56:59], v[16:19], a[72:75], v[56:59]
    ds_read_b128 v[40:43], v5 offset:33792
    v_mfma_f32_16x16x32_bf16 v[76:79], v[16:19], a[76:79], v[76:79]
    ds_read_b128 v[44:47], v5 offset:34816
    v_mfma_f32_16x16x32_bf16 v[60:63], v[20:23], a[72:75], v[60:63]
    ds_read_b128 v[48:51], v5 offset:35840
    buffer_load_dwordx4 a[120:123], v5, s[4:7], s20 offen offset:3072
    v_mfma_f32_16x16x32_bf16 v[80:83], v[20:23], a[76:79], v[80:83]
    v_mfma_f32_16x16x32_bf16 v[64:67], v[24:27], a[72:75], v[64:67]
    v_mfma_f32_16x16x32_bf16 v[84:87], v[24:27], a[76:79], v[84:87]
    v_mfma_f32_16x16x32_bf16 v[136:139], v[152:155], a[72:75], v[136:139]
    buffer_load_dwordx4 a[124:127], v5, s[4:7], s35 offen offset:3072
    s_add_u32 s20, s20, 4096
    v_mfma_f32_16x16x32_bf16 v[144:147], a[72:75], a[72:75], v[144:147]
    s_add_u32 s35, s35, 4096
    v_mfma_f32_16x16x32_bf16 v[140:143], v[152:155], a[76:79], v[140:143]
    v_mfma_f32_16x16x32_bf16 v[148:151], a[76:79], a[76:79], v[148:151]
    s_waitcnt lgkmcnt(3)
    s_waitcnt vmcnt(13)
    s_barrier
    v_mfma_f32_16x16x32_bf16 v[56:59], v[28:31], a[80:83], v[56:59]
    ds_read_b128 v[16:19], v5 offset:36864
    buffer_load_dwordx4 a[128:131], v5, s[4:7], s20 offen offset:0
    v_mfma_f32_16x16x32_bf16 v[76:79], v[28:31], a[84:87], v[76:79]
    ds_read_b128 v[20:23], v5 offset:37888
    v_mfma_f32_16x16x32_bf16 v[60:63], v[32:35], a[80:83], v[60:63]
    ds_read_b128 v[24:27], v5 offset:38912
    v_mfma_f32_16x16x32_bf16 v[80:83], v[32:35], a[84:87], v[80:83]
    v_mfma_f32_16x16x32_bf16 v[64:67], v[36:39], a[80:83], v[64:67]
    buffer_load_dwordx4 a[132:135], v5, s[4:7], s35 offen offset:0
    v_mfma_f32_16x16x32_bf16 v[84:87], v[36:39], a[84:87], v[84:87]
    v_mfma_f32_16x16x32_bf16 v[136:139], v[152:155], a[80:83], v[136:139]
    v_mfma_f32_16x16x32_bf16 v[144:147], a[80:83], a[80:83], v[144:147]
    v_mfma_f32_16x16x32_bf16 v[140:143], v[152:155], a[84:87], v[140:143]
    buffer_load_dwordx4 a[136:139], v5, s[4:7], s20 offen offset:1024
    v_mfma_f32_16x16x32_bf16 v[148:151], a[84:87], a[84:87], v[148:151]
    s_waitcnt lgkmcnt(3)
    s_waitcnt vmcnt(14)
    v_mfma_f32_16x16x32_bf16 v[56:59], v[40:43], a[88:91], v[56:59]
    ds_read_b128 v[28:31], v5 offset:39936
    v_mfma_f32_16x16x32_bf16 v[76:79], v[40:43], a[92:95], v[76:79]
    ds_read_b128 v[32:35], v5 offset:40960
    v_mfma_f32_16x16x32_bf16 v[60:63], v[44:47], a[88:91], v[60:63]
    ds_read_b128 v[36:39], v5 offset:41984
    buffer_load_dwordx4 a[140:143], v5, s[4:7], s35 offen offset:1024
    v_mfma_f32_16x16x32_bf16 v[80:83], v[44:47], a[92:95], v[80:83]
    v_mfma_f32_16x16x32_bf16 v[64:67], v[48:51], a[88:91], v[64:67]
    v_mfma_f32_16x16x32_bf16 v[84:87], v[48:51], a[92:95], v[84:87]
    v_mfma_f32_16x16x32_bf16 v[136:139], v[152:155], a[88:91], v[136:139]
    buffer_load_dwordx4 a[144:147], v5, s[4:7], s20 offen offset:2048
    v_mfma_f32_16x16x32_bf16 v[144:147], a[88:91], a[88:91], v[144:147]
    v_mfma_f32_16x16x32_bf16 v[140:143], v[152:155], a[92:95], v[140:143]
    v_mfma_f32_16x16x32_bf16 v[148:151], a[92:95], a[92:95], v[148:151]
    s_waitcnt lgkmcnt(3)
    s_waitcnt vmcnt(14)
    v_mfma_f32_16x16x32_bf16 v[56:59], v[16:19], a[96:99], v[56:59]
    ds_read_b128 v[40:43], v5 offset:43008
    buffer_load_dwordx4 a[148:151], v5, s[4:7], s35 offen offset:2048
    v_mfma_f32_16x16x32_bf16 v[76:79], v[16:19], a[100:103], v[76:79]
    ds_read_b128 v[44:47], v5 offset:44032
    v_mfma_f32_16x16x32_bf16 v[60:63], v[20:23], a[96:99], v[60:63]
    ds_read_b128 v[48:51], v5 offset:45056
    v_mfma_f32_16x16x32_bf16 v[80:83], v[20:23], a[100:103], v[80:83]
    v_mfma_f32_16x16x32_bf16 v[64:67], v[24:27], a[96:99], v[64:67]
    buffer_load_dwordx4 a[152:155], v5, s[4:7], s20 offen offset:3072
    v_mfma_f32_16x16x32_bf16 v[84:87], v[24:27], a[100:103], v[84:87]
    v_mfma_f32_16x16x32_bf16 v[136:139], v[152:155], a[96:99], v[136:139]
    v_mfma_f32_16x16x32_bf16 v[144:147], a[96:99], a[96:99], v[144:147]
    v_mfma_f32_16x16x32_bf16 v[140:143], v[152:155], a[100:103], v[140:143]
    buffer_load_dwordx4 a[156:159], v5, s[4:7], s35 offen offset:3072
    s_add_u32 m0, s65, 61440
    v_mfma_f32_16x16x32_bf16 v[148:151], a[100:103], a[100:103], v[148:151]
    s_waitcnt lgkmcnt(3)
    s_waitcnt vmcnt(15)
    v_mfma_f32_16x16x32_bf16 v[56:59], v[28:31], a[104:107], v[56:59]
    ds_read_b128 v[16:19], v5 offset:46080
    v_mfma_f32_16x16x32_bf16 v[76:79], v[28:31], a[108:111], v[76:79]
    ds_read_b128 v[20:23], v5 offset:47104
    v_mfma_f32_16x16x32_bf16 v[60:63], v[32:35], a[104:107], v[60:63]
    ds_read_b128 v[24:27], v5 offset:48128
    buffer_load_dwordx4 v5, s[8:11], m0 offen lds
    v_mfma_f32_16x16x32_bf16 v[80:83], v[32:35], a[108:111], v[80:83]
    s_add_u32 m0, s65, 62464
    v_mfma_f32_16x16x32_bf16 v[64:67], v[36:39], a[104:107], v[64:67]
    v_mfma_f32_16x16x32_bf16 v[84:87], v[36:39], a[108:111], v[84:87]
    v_mfma_f32_16x16x32_bf16 v[136:139], v[152:155], a[104:107], v[136:139]
    buffer_load_dwordx4 v5, s[8:11], m0 offen lds
    s_add_u32 m0, s65, 69632
    v_mfma_f32_16x16x32_bf16 v[144:147], a[104:107], a[104:107], v[144:147]
    v_mfma_f32_16x16x32_bf16 v[140:143], v[152:155], a[108:111], v[140:143]
    v_mfma_f32_16x16x32_bf16 v[148:151], a[108:111], a[108:111], v[148:151]
    s_waitcnt lgkmcnt(3)
    s_waitcnt vmcnt(12)
    s_barrier
    v_mfma_f32_16x16x32_bf16 v[56:59], v[40:43], a[112:115], v[56:59]
    ds_read_b128 v[28:31], v5 offset:49152
    buffer_load_dwordx4 v5, s[8:11], m0 offen lds
    v_mfma_f32_16x16x32_bf16 v[76:79], v[40:43], a[116:119], v[76:79]
    ds_read_b128 v[32:35], v5 offset:50176
    s_add_u32 m0, s65, 70656
    v_mfma_f32_16x16x32_bf16 v[60:63], v[44:47], a[112:115], v[60:63]
    ds_read_b128 v[36:39], v5 offset:51200
    v_mfma_f32_16x16x32_bf16 v[80:83], v[44:47], a[116:119], v[80:83]
    v_mfma_f32_16x16x32_bf16 v[64:67], v[48:51], a[112:115], v[64:67]
    buffer_load_dwordx4 v5, s[8:11], m0 offen lds
    s_add_u32 m0, s65, 77824
    v_mfma_f32_16x16x32_bf16 v[84:87], v[48:51], a[116:119], v[84:87]
    v_mfma_f32_16x16x32_bf16 v[136:139], v[152:155], a[112:115], v[136:139]
    v_mfma_f32_16x16x32_bf16 v[144:147], a[112:115], a[112:115], v[144:147]
    v_mfma_f32_16x16x32_bf16 v[140:143], v[152:155], a[116:119], v[140:143]
    buffer_load_dwordx4 v5, s[8:11], m0 offen lds
    s_add_u32 m0, s65, 78848
    v_mfma_f32_16x16x32_bf16 v[148:151], a[116:119], a[116:119], v[148:151]
    s_waitcnt lgkmcnt(3)
    s_waitcnt vmcnt(13)
    v_mfma_f32_16x16x32_bf16 v[56:59], v[16:19], a[120:123], v[56:59]
    ds_read_b128 v[40:43], v5 offset:52224
    v_mfma_f32_16x16x32_bf16 v[76:79], v[16:19], a[124:127], v[76:79]
    ds_read_b128 v[44:47], v5 offset:53248
    v_mfma_f32_16x16x32_bf16 v[60:63], v[20:23], a[120:123], v[60:63]
    ds_read_b128 v[48:51], v5 offset:54272
    buffer_load_dwordx4 v5, s[8:11], m0 offen lds
    v_mfma_f32_16x16x32_bf16 v[80:83], v[20:23], a[124:127], v[80:83]
    s_add_u32 m0, s65, 86016
    v_mfma_f32_16x16x32_bf16 v[64:67], v[24:27], a[120:123], v[64:67]
    v_mfma_f32_16x16x32_bf16 v[84:87], v[24:27], a[124:127], v[84:87]
    v_mfma_f32_16x16x32_bf16 v[136:139], v[152:155], a[120:123], v[136:139]
    buffer_load_dwordx4 v5, s[8:11], m0 offen lds
    s_add_u32 m0, s65, 87040
    v_mfma_f32_16x16x32_bf16 v[144:147], a[120:123], a[120:123], v[144:147]
    v_mfma_f32_16x16x32_bf16 v[140:143], v[152:155], a[124:127], v[140:143]
    v_mfma_f32_16x16x32_bf16 v[148:151], a[124:127], a[124:127], v[148:151]
    s_waitcnt lgkmcnt(3)
    s_waitcnt vmcnt(13)
    v_mfma_f32_16x16x32_bf16 v[56:59], v[28:31], a[128:131], v[56:59]
    ds_read_b128 v[16:19], v5 offset:55296
    buffer_load_dwordx4 v5, s[8:11], m0 offen lds
    v_mfma_f32_16x16x32_bf16 v[76:79], v[28:31], a[132:135], v[76:79]
    ds_read_b128 v[20:23], v5 offset:56320
    s_add_u32 m0, s65, 94208
    v_mfma_f32_16x16x32_bf16 v[60:63], v[32:35], a[128:131], v[60:63]
    ds_read_b128 v[24:27], v5 offset:57344
    v_mfma_f32_16x16x32_bf16 v[80:83], v[32:35], a[132:135], v[80:83]
    v_mfma_f32_16x16x32_bf16 v[64:67], v[36:39], a[128:131], v[64:67]
    buffer_load_dwordx4 v5, s[8:11], m0 offen lds
    s_add_u32 m0, s65, 95232
    v_mfma_f32_16x16x32_bf16 v[84:87], v[36:39], a[132:135], v[84:87]
    v_mfma_f32_16x16x32_bf16 v[136:139], v[152:155], a[128:131], v[136:139]
    v_mfma_f32_16x16x32_bf16 v[144:147], a[128:131], a[128:131], v[144:147]
    v_mfma_f32_16x16x32_bf16 v[140:143], v[152:155], a[132:135], v[140:143]
    buffer_load_dwordx4 v5, s[8:11], m0 offen lds
    v_mfma_f32_16x16x32_bf16 v[148:151], a[132:135], a[132:135], v[148:151]
    s_waitcnt lgkmcnt(3)
    s_waitcnt vmcnt(14)
    v_mfma_f32_16x16x32_bf16 v[56:59], v[40:43], a[136:139], v[56:59]
    ds_read_b128 v[28:31], v5 offset:58368
    v_mfma_f32_16x16x32_bf16 v[76:79], v[40:43], a[140:143], v[76:79]
    ds_read_b128 v[32:35], v5 offset:59392
    v_mfma_f32_16x16x32_bf16 v[60:63], v[44:47], a[136:139], v[60:63]
    ds_read_b128 v[36:39], v5 offset:60416
    v_mfma_f32_16x16x32_bf16 v[80:83], v[44:47], a[140:143], v[80:83]
    v_mfma_f32_16x16x32_bf16 v[64:67], v[48:51], a[136:139], v[64:67]
    v_mfma_f32_16x16x32_bf16 v[84:87], v[48:51], a[140:143], v[84:87]
    v_mfma_f32_16x16x32_bf16 v[136:139], v[152:155], a[136:139], v[136:139]
    v_mfma_f32_16x16x32_bf16 v[144:147], a[136:139], a[136:139], v[144:147]
    v_mfma_f32_16x16x32_bf16 v[140:143], v[152:155], a[140:143], v[140:143]
    v_mfma_f32_16x16x32_bf16 v[148:151], a[140:143], a[140:143], v[148:151]
    s_waitcnt lgkmcnt(3)
    s_waitcnt vmcnt(12)
    v_mfma_f32_16x16x32_bf16 v[56:59], v[16:19], a[144:147], v[56:59]
    v_mfma_f32_16x16x32_bf16 v[76:79], v[16:19], a[148:151], v[76:79]
    v_mfma_f32_16x16x32_bf16 v[60:63], v[20:23], a[144:147], v[60:63]
    v_mfma_f32_16x16x32_bf16 v[80:83], v[20:23], a[148:151], v[80:83]
    v_mfma_f32_16x16x32_bf16 v[64:67], v[24:27], a[144:147], v[64:67]
    v_mfma_f32_16x16x32_bf16 v[84:87], v[24:27], a[148:151], v[84:87]
    v_mfma_f32_16x16x32_bf16 v[136:139], v[152:155], a[144:147], v[136:139]
    v_mfma_f32_16x16x32_bf16 v[144:147], a[144:147], a[144:147], v[144:147]
    v_mfma_f32_16x16x32_bf16 v[140:143], v[152:155], a[148:151], v[140:143]
    v_mfma_f32_16x16x32_bf16 v[148:151], a[148:151], a[148:151], v[148:151]
    s_waitcnt lgkmcnt(0)
    s_waitcnt vmcnt(10)
    v_mfma_f32_16x16x32_bf16 v[56:59], v[28:31], a[152:155], v[56:59]
    v_mfma_f32_16x16x32_bf16 v[76:79], v[28:31], a[156:159], v[76:79]
    v_mfma_f32_16x16x32_bf16 v[60:63], v[32:35], a[152:155], v[60:63]
    v_mfma_f32_16x16x32_bf16 v[80:83], v[32:35], a[156:159], v[80:83]
    v_mfma_f32_16x16x32_bf16 v[64:67], v[36:39], a[152:155], v[64:67]
    v_mfma_f32_16x16x32_bf16 v[84:87], v[36:39], a[156:159], v[84:87]
    v_mfma_f32_16x16x32_bf16 v[136:139], v[152:155], a[152:155], v[136:139]
    v_mfma_f32_16x16x32_bf16 v[144:147], a[152:155], a[152:155], v[144:147]
    v_mfma_f32_16x16x32_bf16 v[140:143], v[152:155], a[156:159], v[140:143]
    v_mfma_f32_16x16x32_bf16 v[148:151], a[156:159], a[156:159], v[148:151]
    s_waitcnt vmcnt(8)
    s_barrier
    ds_read_b128 v[16:19], v6 offset:0
    ds_read_b128 v[20:23], v6 offset:1024
    ds_read_b128 v[24:27], v6 offset:2048
    ds_read_b128 v[28:31], v6 offset:3072
    ds_read_b128 v[32:35], v6 offset:4096
    ds_read_b128 v[36:39], v6 offset:5120
    s_waitcnt lgkmcnt(2)
    v_mfma_f32_16x16x32_bf16 v[68:71], v[16:19], a[0:3], 0
    ds_read_b128 v[40:43], v6 offset:6144
    s_add_u32 m0, s64, 102400
    v_mfma_f32_16x16x32_bf16 v[88:91], v[16:19], a[4:7], 0
    ds_read_b128 v[44:47], v6 offset:7168
    buffer_load_dwordx4 v5, s[8:11], m0 offen lds
    v_mfma_f32_16x16x32_bf16 v[72:75], v[20:23], a[0:3], 0
    s_add_u32 m0, s64, 103424
    v_cndmask_b32 v144, v144, v145, s[24:25]
    v_mfma_f32_16x16x32_bf16 v[92:95], v[20:23], a[4:7], 0
    v_cndmask_b32 v146, v146, v147, s[28:29]
    v_cndmask_b32 v146, v144, v146, s[22:23]
    s_waitcnt vmcnt(7)
    s_barrier
    v_mfma_f32_16x16x32_bf16 v[68:71], v[24:27], a[8:11], v[68:71]
    ds_read_b128 v[16:19], v6 offset:8192
    buffer_load_dwordx4 v5, s[8:11], m0 offen lds
    v_mfma_f32_16x16x32_bf16 v[88:91], v[24:27], a[12:15], v[88:91]
    ds_read_b128 v[20:23], v6 offset:9216
    s_add_u32 m0, s64, 104448
    v_mfma_f32_16x16x32_bf16 v[72:75], v[28:31], a[8:11], v[72:75]
    v_cndmask_b32 v148, v148, v149, s[24:25]
    v_cndmask_b32 v150, v150, v151, s[28:29]
    v_mfma_f32_16x16x32_bf16 v[92:95], v[28:31], a[12:15], v[92:95]
    buffer_load_dwordx4 v5, s[8:11], m0 offen lds
    s_add_u32 m0, s64, 114688
    s_waitcnt lgkmcnt(2)
    v_mfma_f32_16x16x32_bf16 v[68:71], v[32:35], a[16:19], v[68:71]
    ds_read_b128 v[24:27], v6 offset:10240
    v_cndmask_b32 v150, v148, v150, s[22:23]
    v_mfma_f32_16x16x32_bf16 v[88:91], v[32:35], a[20:23], v[88:91]
    ds_read_b128 v[28:31], v6 offset:11264
    ds_bpermute_b32 v145, v9, v146
    v_mfma_f32_16x16x32_bf16 v[72:75], v[36:39], a[16:19], v[72:75]
    buffer_load_dwordx4 v5, s[8:11], m0 offen lds
    s_add_u32 m0, s64, 115712
    v_mfma_f32_16x16x32_bf16 v[92:95], v[36:39], a[20:23], v[92:95]
    ds_bpermute_b32 v149, v9, v150
    v_mul_f32 v136, 0.0015625, v136
    v_mfma_f32_16x16x32_bf16 v[68:71], v[40:43], a[24:27], v[68:71]
    ds_read_b128 v[32:35], v6 offset:12288
    v_mul_f32 v140, 0.0015625, v140
    v_mfma_f32_16x16x32_bf16 v[88:91], v[40:43], a[28:31], v[88:91]
    ds_read_b128 v[36:39], v6 offset:13312
    buffer_load_dwordx4 v5, s[8:11], m0 offen lds
    v_mfma_f32_16x16x32_bf16 v[72:75], v[44:47], a[24:27], v[72:75]
    s_add_u32 m0, s64, 116736
    v_mfma_f32_16x16x32_bf16 v[92:95], v[44:47], a[28:31], v[92:95]
    s_waitcnt lgkmcnt(0)
    v_mfma_f32_16x16x32_bf16 v[68:71], v[16:19], a[32:35], v[68:71]
    ds_read_b128 v[40:43], v6 offset:14336
    buffer_load_dwordx4 v5, s[8:11], m0 offen lds
    v_mfma_f32_16x16x32_bf16 v[88:91], v[16:19], a[36:39], v[88:91]
    ds_read_b128 v[44:47], v6 offset:15360
    s_add_u32 m0, s64, 126976
    v_mfma_f32_16x16x32_bf16 v[72:75], v[20:23], a[32:35], v[72:75]
    v_mul_f32 v145, 0.0015625, v145
    v_mul_f32 v149, 0.0015625, v149
    v_mfma_f32_16x16x32_bf16 v[92:95], v[20:23], a[36:39], v[92:95]
    buffer_load_dwordx4 v5, s[8:11], m0 offen lds
    s_add_u32 m0, s64, 128000
    s_waitcnt vmcnt(11)
    s_barrier
    v_mfma_f32_16x16x32_bf16 v[68:71], v[24:27], a[40:43], v[68:71]
    ds_read_b128 v[16:19], v6 offset:16384
    v_fma_f32 v145, -v136, v136, v145
    v_mfma_f32_16x16x32_bf16 v[88:91], v[24:27], a[44:47], v[88:91]
    ds_read_b128 v[20:23], v6 offset:17408
    v_fma_f32 v149, -v140, v140, v149
    v_mfma_f32_16x16x32_bf16 v[72:75], v[28:31], a[40:43], v[72:75]
    buffer_load_dwordx4 v5, s[8:11], m0 offen lds
    s_add_u32 m0, s64, 129024
    v_mfma_f32_16x16x32_bf16 v[92:95], v[28:31], a[44:47], v[92:95]
    v_max_f32 v145, 0, v145
    v_max_f32 v149, 0, v149
    s_waitcnt lgkmcnt(2)
    v_mfma_f32_16x16x32_bf16 v[68:71], v[32:35], a[48:51], v[68:71]
    ds_read_b128 v[24:27], v6 offset:18432
    v_add_f32 v145, 0x3727c5ac, v145
    v_mfma_f32_16x16x32_bf16 v[88:91], v[32:35], a[52:55], v[88:91]
    ds_read_b128 v[28:31], v6 offset:19456
    buffer_load_dwordx4 v5, s[8:11], m0 offen lds
    v_mfma_f32_16x16x32_bf16 v[72:75], v[36:39], a[48:51], v[72:75]
    s_add_u32 m0, s64, 139264
    v_add_f32 v149, 0x3727c5ac, v149
    v_mfma_f32_16x16x32_bf16 v[92:95], v[36:39], a[52:55], v[92:95]
    v_rsq_f32 v10, v145
    v_mfma_f32_16x16x32_bf16 v[68:71], v[40:43], a[56:59], v[68:71]
    ds_read_b128 v[32:35], v6 offset:20480
    buffer_load_dwordx4 v5, s[8:11], m0 offen lds
    v_mfma_f32_16x16x32_bf16 v[88:91], v[40:43], a[60:63], v[88:91]
    ds_read_b128 v[36:39], v6 offset:21504
    s_add_u32 m0, s64, 140288
    v_mfma_f32_16x16x32_bf16 v[72:75], v[44:47], a[56:59], v[72:75]
    v_rsq_f32 v11, v149
    v_mfma_f32_16x16x32_bf16 v[92:95], v[44:47], a[60:63], v[92:95]
    buffer_load_dwordx4 v5, s[8:11], m0 offen lds
    s_add_u32 m0, s64, 141312
    s_waitcnt lgkmcnt(2)
    v_mfma_f32_16x16x32_bf16 v[68:71], v[16:19], a[64:67], v[68:71]
    ds_read_b128 v[40:43], v6 offset:22528
    v_mov_b32 v205, 0x3f80
    v_mfma_f32_16x16x32_bf16 v[88:91], v[16:19], a[68:71], v[88:91]
    ds_read_b128 v[44:47], v6 offset:23552
    v_mov_b32 v213, 0x3f80
    v_mfma_f32_16x16x32_bf16 v[72:75], v[20:23], a[64:67], v[72:75]
    buffer_load_dwordx4 v5, s[8:11], m0 offen lds
    s_add_u32 m0, s64, 151552
    v_mfma_f32_16x16x32_bf16 v[92:95], v[20:23], a[68:71], v[92:95]
    v_mul_f32 v14, 1.4426950408889634, v10
    v_mul_f32 v15, 1.4426950408889634, v11
    s_waitcnt vmcnt(14)
    s_barrier
    v_mfma_f32_16x16x32_bf16 v[68:71], v[24:27], a[72:75], v[68:71]
    ds_read_b128 v[16:19], v6 offset:24576
    v_mov_b32 v206, 0
    v_mfma_f32_16x16x32_bf16 v[88:91], v[24:27], a[76:79], v[88:91]
    ds_read_b128 v[20:23], v6 offset:25600
    buffer_load_dwordx4 v5, s[8:11], m0 offen lds
    v_mfma_f32_16x16x32_bf16 v[72:75], v[28:31], a[72:75], v[72:75]
    s_add_u32 m0, s64, 152576
    v_mov_b32 v207, 0
    v_mfma_f32_16x16x32_bf16 v[92:95], v[28:31], a[76:79], v[92:95]
    v_mov_b32 v214, 0
    v_mov_b32 v215, 0
    s_waitcnt lgkmcnt(2)
    v_mfma_f32_16x16x32_bf16 v[68:71], v[32:35], a[80:83], v[68:71]
    ds_read_b128 v[24:27], v6 offset:26624
    buffer_load_dwordx4 v5, s[8:11], m0 offen lds
    v_mfma_f32_16x16x32_bf16 v[88:91], v[32:35], a[84:87], v[88:91]
    ds_read_b128 v[28:31], v6 offset:27648
    s_add_u32 m0, s64, 153600
    v_mfma_f32_16x16x32_bf16 v[72:75], v[36:39], a[80:83], v[72:75]
    v_max3_f32 v216, v56, v57, v58
    v_min3_f32 v218, v56, v57, v58
    v_mfma_f32_16x16x32_bf16 v[92:95], v[36:39], a[84:87], v[92:95]
    buffer_load_dwordx4 v5, s[8:11], m0 offen lds
    v_max3_f32 v217, v76, v77, v78
    v_mfma_f32_16x16x32_bf16 v[68:71], v[40:43], a[88:91], v[68:71]
    ds_read_b128 v[32:35], v6 offset:28672
    v_min3_f32 v219, v76, v77, v78
    v_mfma_f32_16x16x32_bf16 v[88:91], v[40:43], a[92:95], v[88:91]
    ds_read_b128 v[36:39], v6 offset:29696
    v_max3_f32 v216, v216, v59, v60
    v_mfma_f32_16x16x32_bf16 v[72:75], v[44:47], a[88:91], v[72:75]
    v_min3_f32 v218, v218, v59, v60
    v_max3_f32 v217, v217, v79, v80
    v_mfma_f32_16x16x32_bf16 v[92:95], v[44:47], a[92:95], v[92:95]
    v_min3_f32 v219, v219, v79, v80
    v_max3_f32 v216, v216, v61, v62
    s_waitcnt lgkmcnt(2)
    v_mfma_f32_16x16x32_bf16 v[68:71], v[16:19], a[96:99], v[68:71]
    ds_read_b128 v[40:43], v6 offset:30720
    v_min3_f32 v218, v218, v61, v62
    v_mfma_f32_16x16x32_bf16 v[88:91], v[16:19], a[100:103], v[88:91]
    ds_read_b128 v[44:47], v6 offset:31744
    v_max3_f32 v217, v217, v81, v82
    v_mfma_f32_16x16x32_bf16 v[72:75], v[20:23], a[96:99], v[72:75]
    v_min3_f32 v219, v219, v81, v82
    v_max3_f32 v216, v216, v63, v64
    v_mfma_f32_16x16x32_bf16 v[92:95], v[20:23], a[100:103], v[92:95]
    v_min3_f32 v218, v218, v63, v64
    v_max3_f32 v217, v217, v83, v84
    s_waitcnt vmcnt(15)
    s_barrier
    v_mfma_f32_16x16x32_bf16 v[68:71], v[24:27], a[104:107], v[68:71]
    ds_read_b128 v[16:19], v6 offset:32768
    v_min3_f32 v219, v219, v83, v84
    v_mfma_f32_16x16x32_bf16 v[88:91], v[24:27], a[108:111], v[88:91]
    ds_read_b128 v[20:23], v6 offset:33792
    v_max_f32 v216, v216, v65
    v_mfma_f32_16x16x32_bf16 v[72:75], v[28:31], a[104:107], v[72:75]
    v_min_f32 v218, v218, v65
    v_max_f32 v217, v217, v85
    v_mfma_f32_16x16x32_bf16 v[92:95], v[28:31], a[108:111], v[92:95]
    v_min_f32 v219, v219, v85
    v_permlane16_swap_b32 v216, v217
    s_waitcnt lgkmcnt(2)
    v_mfma_f32_16x16x32_bf16 v[68:71], v[32:35], a[112:115], v[68:71]
    ds_read_b128 v[24:27], v6 offset:34816
    v_mfma_f32_16x16x32_bf16 v[88:91], v[32:35], a[116:119], v[88:91]
    ds_read_b128 v[28:31], v6 offset:35840
    v_permlane16_swap_b32 v218, v219
    v_mfma_f32_16x16x32_bf16 v[72:75], v[36:39], a[112:115], v[72:75]
    v_max_f32 v216, v216, v217
    v_mfma_f32_16x16x32_bf16 v[92:95], v[36:39], a[116:119], v[92:95]
    v_min_f32 v218, v218, v219
    v_mov_b32 v217, v216
    v_mfma_f32_16x16x32_bf16 v[68:71], v[40:43], a[120:123], v[68:71]
    ds_read_b128 v[32:35], v6 offset:36864
    v_mov_b32 v219, v218
    v_mfma_f32_16x16x32_bf16 v[88:91], v[40:43], a[124:127], v[88:91]
    ds_read_b128 v[36:39], v6 offset:37888
    v_permlane16_swap_b32 v216, v217
    v_mfma_f32_16x16x32_bf16 v[72:75], v[44:47], a[120:123], v[72:75]
    v_permlane16_swap_b32 v218, v219
    v_mfma_f32_16x16x32_bf16 v[92:95], v[44:47], a[124:127], v[92:95]
    v_mul_f32 v216, v14, v216
    s_waitcnt lgkmcnt(2)
    v_mfma_f32_16x16x32_bf16 v[68:71], v[16:19], a[128:131], v[68:71]
    ds_read_b128 v[40:43], v6 offset:38912
    v_mul_f32 v218, v14, v218
    v_mfma_f32_16x16x32_bf16 v[88:91], v[16:19], a[132:135], v[88:91]
    ds_read_b128 v[44:47], v6 offset:39936
    v_mul_f32 v217, v15, v217
    v_mfma_f32_16x16x32_bf16 v[72:75], v[20:23], a[128:131], v[72:75]
    v_mul_f32 v219, v15, v219
    v_fma_f32 v156, v56, v14, -v216
    v_mfma_f32_16x16x32_bf16 v[92:95], v[20:23], a[132:135], v[92:95]
    v_fma_f32 v56, -v56, v14, v218
    v_fma_f32 v166, v76, v15, -v217
    v_mfma_f32_16x16x32_bf16 v[68:71], v[24:27], a[136:139], v[68:71]
    v_fma_f32 v76, -v76, v15, v219
    v_fma_f32 v157, v57, v14, -v216
    v_mfma_f32_16x16x32_bf16 v[88:91], v[24:27], a[140:143], v[88:91]
    v_fma_f32 v57, -v57, v14, v218
    v_exp_f32 v156, v156
    v_mfma_f32_16x16x32_bf16 v[72:75], v[28:31], a[136:139], v[72:75]
    v_exp_f32 v56, v56
    v_mfma_f32_16x16x32_bf16 v[92:95], v[28:31], a[140:143], v[92:95]
    v_fma_f32 v167, v77, v15, -v217
    s_waitcnt lgkmcnt(0)
    s_waitcnt vmcnt(12)
    s_barrier
    v_mfma_f32_16x16x32_bf16 v[68:71], v[32:35], a[144:147], v[68:71]
    v_fma_f32 v77, -v77, v15, v219
    v_exp_f32 v166, v166
    v_mfma_f32_16x16x32_bf16 v[88:91], v[32:35], a[148:151], v[88:91]
    v_exp_f32 v76, v76
    v_mfma_f32_16x16x32_bf16 v[72:75], v[36:39], a[144:147], v[72:75]
    v_fma_f32 v158, v58, v14, -v216
    v_mfma_f32_16x16x32_bf16 v[92:95], v[36:39], a[148:151], v[92:95]
    v_fma_f32 v58, -v58, v14, v218
    v_exp_f32 v157, v157
    v_mfma_f32_16x16x32_bf16 v[68:71], v[40:43], a[152:155], v[68:71]
    v_exp_f32 v57, v57
    v_mfma_f32_16x16x32_bf16 v[88:91], v[40:43], a[156:159], v[88:91]
    v_fma_f32 v168, v78, v15, -v217
    v_mfma_f32_16x16x32_bf16 v[72:75], v[44:47], a[152:155], v[72:75]
    v_fma_f32 v78, -v78, v15, v219
    v_exp_f32 v167, v167
    v_mfma_f32_16x16x32_bf16 v[92:95], v[44:47], a[156:159], v[92:95]
    v_exp_f32 v77, v77
    ds_read_b128 v[16:19], v7 offset:0
    ds_read_b128 v[20:23], v7 offset:1024
    ds_read_b128 v[24:27], v7 offset:2048
    ds_read_b128 v[28:31], v7 offset:3072
    ds_read_b128 v[32:35], v7 offset:4096
    ds_read_b128 v[36:39], v7 offset:5120
    s_cmp_lg_u32 s32, 0
    s_cbranch_scc1 kA_nokclr
    v_mov_b32 v232, -1
    v_mov_b32 v233, -1
    v_mov_b32 v234, -1
    v_mov_b32 v235, -1
    v_subrev_u32 v8, 51200, v251
    s_lshl_b32 s3, s2, 12
    s_add_u32 s3, s3, 16580608
    buffer_store_dwordx4 v[232:235], v8, s[12:15], s3 offen sc1
kA_nokclr:
    v_mul_f32 v66, v10, v66
    v_mul_f32 v67, v10, v67
    v_mul_f32 v68, v10, v68
    v_mul_f32 v69, v10, v69
    v_mul_f32 v70, v10, v70
    v_mul_f32 v71, v10, v71
    v_mul_f32 v72, v10, v72
    v_mul_f32 v73, v10, v73
    v_mul_f32 v74, v10, v74
    v_mul_f32 v75, v10, v75
    v_cvt_pk_bf16_f32 v200, v66, v67
    v_cvt_pk_bf16_f32 v201, v68, v69
    v_cvt_pk_bf16_f32 v202, v70, v71
    v_cvt_pk_bf16_f32 v203, v72, v73
    v_cvt_pk_bf16_f32 v204, v74, v75
    ds_write_b128 v245, v[200:203] offset:0
    ds_write_b128 v245, v[204:207] offset:16
    v_mul_f32 v86, v11, v86
    v_mul_f32 v87, v11, v87
    v_mul_f32 v88, v11, v88
    v_mul_f32 v89, v11, v89
    v_mul_f32 v90, v11, v90
    v_mul_f32 v91, v11, v91
    v_mul_f32 v92, v11, v92
    v_mul_f32 v93, v11, v93
    v_mul_f32 v94, v11, v94
    v_mul_f32 v95, v11, v95
    v_cvt_pk_bf16_f32 v208, v86, v87
    v_cvt_pk_bf16_f32 v209, v88, v89
    v_cvt_pk_bf16_f32 v210, v90, v91
    v_cvt_pk_bf16_f32 v211, v92, v93
    v_cvt_pk_bf16_f32 v212, v94, v95
    ds_write_b128 v245, v[208:211] offset:5632
    ds_write_b128 v245, v[212:215] offset:5648
    v_fma_f32 v159, v59, v14, -v216
    v_fma_f32 v59, -v59, v14, v218
    v_exp_f32 v158, v158
    v_exp_f32 v58, v58
    v_add_f32 v220, v156, v157
    v_add_f32 v222, v56, v57
    v_fma_f32 v169, v79, v15, -v217
    v_fma_f32 v79, -v79, v15, v219
    v_exp_f32 v168, v168
    v_exp_f32 v78, v78
    v_add_f32 v221, v166, v167
    v_add_f32 v223, v76, v77
    v_fma_f32 v160, v60, v14, -v216
    v_fma_f32 v60, -v60, v14, v218
    v_exp_f32 v159, v159
    v_exp_f32 v59, v59
    v_add_f32 v220, v220, v158
    v_add_f32 v222, v222, v58
    v_fma_f32 v170, v80, v15, -v217
    v_fma_f32 v80, -v80, v15, v219
    v_exp_f32 v169, v169
    v_exp_f32 v79, v79
    v_add_f32 v221, v221, v168
    v_add_f32 v223, v223, v78
    v_fma_f32 v161, v61, v14, -v216
    v_fma_f32 v61, -v61, v14, v218
    v_exp_f32 v160, v160
    v_exp_f32 v60, v60
    v_add_f32 v220, v220, v159
    v_add_f32 v222, v222, v59
    v_fma_f32 v171, v81, v15, -v217
    v_fma_f32 v81, -v81, v15, v219
    v_exp_f32 v170, v170
    v_exp_f32 v80, v80
    v_add_f32 v221, v221, v169
    v_add_f32 v223, v223, v79
    v_fma_f32 v162, v62, v14, -v216
    v_fma_f32 v62, -v62, v14, v218
    v_exp_f32 v161, v161
    v_exp_f32 v61, v61
    v_add_f32 v220, v220, v160
    v_add_f32 v222, v222, v60
    v_fma_f32 v172, v82, v15, -v217
    v_fma_f32 v82, -v82, v15, v219
    v_exp_f32 v171, v171
    v_exp_f32 v81, v81
    v_add_f32 v221, v221, v170
    v_add_f32 v223, v223, v80
    v_fma_f32 v163, v63, v14, -v216
    v_fma_f32 v63, -v63, v14, v218
    v_exp_f32 v162, v162
    v_exp_f32 v62, v62
    v_add_f32 v220, v220, v161
    v_add_f32 v222, v222, v61
    v_fma_f32 v173, v83, v15, -v217
    v_fma_f32 v83, -v83, v15, v219
    v_exp_f32 v172, v172
    v_exp_f32 v82, v82
    v_add_f32 v221, v221, v171
    v_add_f32 v223, v223, v81
    v_fma_f32 v164, v64, v14, -v216
    v_fma_f32 v64, -v64, v14, v218
    v_exp_f32 v163, v163
    v_exp_f32 v63, v63
    v_add_f32 v220, v220, v162
    v_add_f32 v222, v222, v62
    v_fma_f32 v174, v84, v15, -v217
    v_fma_f32 v84, -v84, v15, v219
    v_exp_f32 v173, v173
    v_exp_f32 v83, v83
    v_add_f32 v221, v221, v172
    v_add_f32 v223, v223, v82
    v_fma_f32 v165, v65, v14, -v216
    v_fma_f32 v65, -v65, v14, v218
    v_exp_f32 v164, v164
    v_exp_f32 v64, v64
    v_add_f32 v220, v220, v163
    v_add_f32 v222, v222, v63
    v_fma_f32 v175, v85, v15, -v217
    v_fma_f32 v85, -v85, v15, v219
    v_exp_f32 v174, v174
    v_exp_f32 v84, v84
    v_add_f32 v221, v221, v173
    v_add_f32 v223, v223, v83
    v_exp_f32 v165, v165
    v_exp_f32 v65, v65
    v_add_f32 v220, v220, v164
    v_add_f32 v222, v222, v64
    v_exp_f32 v175, v175
    v_exp_f32 v85, v85
    v_add_f32 v221, v221, v174
    v_add_f32 v223, v223, v84
    v_add_f32 v220, v220, v165
    v_add_f32 v222, v222, v65
    v_add_f32 v221, v221, v175
    v_add_f32 v223, v223, v85
    s_nop 0
    v_permlane16_swap_b32 v220, v221
    v_permlane16_swap_b32 v222, v223
    v_add_f32 v220, v220, v221
    v_add_f32 v222, v222, v223
    v_rcp_f32 v220, v220
    v_rcp_f32 v222, v222
    v_mov_b32 v221, v220
    v_mov_b32 v223, v222
    s_nop 0
    v_permlane16_swap_b32 v220, v221
    v_permlane16_swap_b32 v222, v223
    v_mul_f32 v156, v220, v156
    v_mul_f32 v56, v222, v56
    v_mul_f32 v157, v220, v157
    v_mul_f32 v57, v222, v57
    v_mul_f32 v158, v220, v158
    v_mul_f32 v58, v222, v58
    v_mul_f32 v159, v220, v159
    v_mul_f32 v59, v222, v59
    v_mul_f32 v160, v220, v160
    v_mul_f32 v60, v222, v60
    v_mul_f32 v161, v220, v161
    v_mul_f32 v61, v222, v61
    v_mul_f32 v162, v220, v162
    v_mul_f32 v62, v222, v62
    v_mul_f32 v163, v220, v163
    v_mul_f32 v63, v222, v63
    v_mul_f32 v164, v220, v164
    v_mul_f32 v64, v222, v64
    v_mul_f32 v165, v220, v165
    v_mul_f32 v65, v222, v65
    v_cvt_pk_bf16_f32 v176, v156, v157
    v_cvt_pk_bf16_f32 v181, v56, v57
    v_cvt_pk_bf16_f32 v177, v158, v159
    v_cvt_pk_bf16_f32 v182, v58, v59
    v_cvt_pk_bf16_f32 v178, v160, v161
    v_cvt_pk_bf16_f32 v183, v60, v61
    v_cvt_pk_bf16_f32 v179, v162, v163
    v_cvt_pk_bf16_f32 v184, v62, v63
    v_cvt_pk_bf16_f32 v180, v164, v165
    v_cvt_pk_bf16_f32 v185, v64, v65
    v_mov_b32 v186, 0
    v_mov_b32 v187, 0
    ds_write_b128 v244, v[176:179] offset:0
    ds_write_b128 v244, v[180:183] offset:16
    ds_write_b128 v244, v[184:187] offset:32
    v_mul_f32 v166, v221, v166
    v_mul_f32 v76, v223, v76
    v_mul_f32 v167, v221, v167
    v_mul_f32 v77, v223, v77
    v_mul_f32 v168, v221, v168
    v_mul_f32 v78, v223, v78
    v_mul_f32 v169, v221, v169
    v_mul_f32 v79, v223, v79
    v_mul_f32 v170, v221, v170
    v_mul_f32 v80, v223, v80
    v_mul_f32 v171, v221, v171
    v_mul_f32 v81, v223, v81
    v_mul_f32 v172, v221, v172
    v_mul_f32 v82, v223, v82
    v_mul_f32 v173, v221, v173
    v_mul_f32 v83, v223, v83
    v_mul_f32 v174, v221, v174
    v_mul_f32 v84, v223, v84
    v_mul_f32 v175, v221, v175
    v_mul_f32 v85, v223, v85
    v_cvt_pk_bf16_f32 v188, v166, v167
    v_cvt_pk_bf16_f32 v193, v76, v77
    v_cvt_pk_bf16_f32 v189, v168, v169
    v_cvt_pk_bf16_f32 v194, v78, v79
    v_cvt_pk_bf16_f32 v190, v170, v171
    v_cvt_pk_bf16_f32 v195, v80, v81
    v_cvt_pk_bf16_f32 v191, v172, v173
    v_cvt_pk_bf16_f32 v196, v82, v83
    v_cvt_pk_bf16_f32 v192, v174, v175
    v_cvt_pk_bf16_f32 v197, v84, v85
    v_mov_b32 v198, 0
    v_mov_b32 v199, 0
    ds_write_b128 v244, v[188:191] offset:5632
    ds_write_b128 v244, v[192:195] offset:5648
    ds_write_b128 v244, v[196:199] offset:5664
    v_mov_b32 v232, 0
    v_mov_b32 v233, 0
    v_mov_b32 v234, 0
    v_mov_b32 v235, 0
    v_add_u32 v8, -2048, v251
    v_cmp_gt_u32 vcc, 128, v0
    s_nop 0
    s_and_saveexec_b64 s[40:41], vcc
    ds_write_b128 v8, v[232:235]
    s_mov_b64 exec, s[40:41]
    s_waitcnt lgkmcnt(0)
    s_barrier
    v_mov_b32 v232, -1
    v_mov_b32 v233, -1
    v_mov_b32 v234, -1
    v_mov_b32 v235, -1
    s_add_u32 s47, s46, 6062080
    s_waitcnt lgkmcnt(14)
    v_mfma_f32_16x16x32_bf16 v[96:99], v[16:19], a[0:3], 0
    ds_read_b128 v[40:43], v7 offset:6144
    ds_read_b64_tr_b16 v[216:217], v247 offset:0
    v_mfma_f32_16x16x32_bf16 v[116:119], v[16:19], a[4:7], 0
    ds_read_b128 v[44:47], v7 offset:7168
    ds_read_b64_tr_b16 v[218:219], v247 offset:5632
    v_mfma_f32_16x16x32_bf16 v[100:103], v[20:23], a[0:3], 0
    ds_read_b128 v[48:51], v7 offset:8192
    ds_read_b64_tr_b16 v[56:57], v246 offset:0
    v_mfma_f32_16x16x32_bf16 v[120:123], v[20:23], a[4:7], 0
    ds_read_b64_tr_b16 v[58:59], v246 offset:5632
    ds_read_b64_tr_b16 v[72:73], v246 offset:32
    v_mfma_f32_16x16x32_bf16 v[104:107], v[24:27], a[0:3], 0
    ds_read_b64_tr_b16 v[74:75], v246 offset:5664
    ds_read_b64_tr_b16 v[156:157], v246 offset:64
    v_mfma_f32_16x16x32_bf16 v[124:127], v[24:27], a[4:7], 0
    ds_read_b64_tr_b16 v[158:159], v246 offset:5696
    ds_read_b64_tr_b16 v[220:221], v247 offset:11264
    s_waitcnt lgkmcnt(15)
    v_mfma_f32_16x16x32_bf16 v[96:99], v[28:31], a[8:11], v[96:99]
    ds_read_b128 v[16:19], v7 offset:9216
    ds_read_b64_tr_b16 v[222:223], v247 offset:16896
    v_mfma_f32_16x16x32_bf16 v[116:119], v[28:31], a[12:15], v[116:119]
    ds_read_b128 v[20:23], v7 offset:10240
    ds_read_b64_tr_b16 v[60:61], v246 offset:11264
    v_mfma_f32_16x16x32_bf16 v[100:103], v[32:35], a[8:11], v[100:103]
    ds_read_b128 v[24:27], v7 offset:11264
    ds_read_b64_tr_b16 v[62:63], v246 offset:16896
    v_mfma_f32_16x16x32_bf16 v[120:123], v[32:35], a[12:15], v[120:123]
    ds_read_b64_tr_b16 v[76:77], v246 offset:11296
    ds_read_b64_tr_b16 v[78:79], v246 offset:16928
    v_mfma_f32_16x16x32_bf16 v[104:107], v[36:39], a[8:11], v[104:107]
    ds_read_b64_tr_b16 v[160:161], v246 offset:11328
    ds_read_b64_tr_b16 v[162:163], v246 offset:16960
    v_mfma_f32_16x16x32_bf16 v[124:127], v[36:39], a[12:15], v[124:127]
    ds_read_b64_tr_b16 v[224:225], v247 offset:22528
    ds_read_b64_tr_b16 v[226:227], v247 offset:28160
    s_waitcnt lgkmcnt(15)
    s_waitcnt vmcnt(9)
    s_barrier
    v_mfma_f32_16x16x32_bf16 v[96:99], v[40:43], a[16:19], v[96:99]
    ds_read_b128 v[28:31], v7 offset:12288
    ds_read_b64_tr_b16 v[64:65], v246 offset:22528
    v_mfma_f32_16x16x32_bf16 v[116:119], v[40:43], a[20:23], v[116:119]
    ds_read_b128 v[32:35], v7 offset:13312
    ds_read_b64_tr_b16 v[66:67], v246 offset:28160
    v_mfma_f32_16x16x32_bf16 v[100:103], v[44:47], a[16:19], v[100:103]
    ds_read_b128 v[36:39], v7 offset:14336
    ds_read_b64_tr_b16 v[80:81], v246 offset:22560
    v_mfma_f32_16x16x32_bf16 v[120:123], v[44:47], a[20:23], v[120:123]
    ds_read_b64_tr_b16 v[82:83], v246 offset:28192
    ds_read_b64_tr_b16 v[164:165], v246 offset:22592
    v_mfma_f32_16x16x32_bf16 v[104:107], v[48:51], a[16:19], v[104:107]
    ds_read_b64_tr_b16 v[166:167], v246 offset:28224
    ds_read_b64_tr_b16 v[228:229], v247 offset:33792
    v_mfma_f32_16x16x32_bf16 v[124:127], v[48:51], a[20:23], v[124:127]
    ds_read_b64_tr_b16 v[230:231], v247 offset:39424
    ds_read_b64_tr_b16 v[68:69], v246 offset:33792
    s_waitcnt lgkmcnt(15)
    v_mfma_f32_16x16x32_bf16 v[96:99], v[16:19], a[24:27], v[96:99]
    ds_read_b128 v[40:43], v7 offset:15360
    ds_read_b64_tr_b16 v[70:71], v246 offset:39424
    v_mfma_f32_16x16x32_bf16 v[116:119], v[16:19], a[28:31], v[116:119]
    ds_read_b128 v[44:47], v7 offset:16384
    ds_read_b64_tr_b16 v[84:85], v246 offset:33824
    v_mfma_f32_16x16x32_bf16 v[100:103], v[20:23], a[24:27], v[100:103]
    ds_read_b128 v[48:51], v7 offset:17408
    ds_read_b64_tr_b16 v[86:87], v246 offset:39456
    v_mfma_f32_16x16x32_bf16 v[120:123], v[20:23], a[28:31], v[120:123]
    ds_read_b64_tr_b16 v[168:169], v246 offset:33856
    ds_read_b64_tr_b16 v[170:171], v246 offset:39488
    v_mfma_f32_16x16x32_bf16 v[104:107], v[24:27], a[24:27], v[104:107]
    buffer_store_dwordx4 v[232:235], v236, s[12:15], s47 offen sc1
    v_mfma_f32_16x16x32_bf16 v[124:127], v[24:27], a[28:31], v[124:127]
    s_waitcnt lgkmcnt(0)
    v_mfma_f32_16x16x32_bf16 v[96:99], v[28:31], a[32:35], v[96:99]
    ds_read_b128 v[16:19], v7 offset:18432
    v_mfma_f32_16x16x32_bf16 v[176:179], v[56:59], v[216:219], 0
    v_mfma_f32_16x16x32_bf16 v[180:183], v[72:75], v[216:219], 0
    v_mfma_f32_16x16x32_bf16 v[184:187], v[156:159], v[216:219], 0
    v_mfma_f32_16x16x32_bf16 v[176:179], v[60:63], v[220:223], v[176:179]
    v_mfma_f32_16x16x32_bf16 v[180:183], v[76:79], v[220:223], v[180:183]
    v_mfma_f32_16x16x32_bf16 v[184:187], v[160:163], v[220:223], v[184:187]
    v_mfma_f32_16x16x32_bf16 v[176:179], v[64:67], v[224:227], v[176:179]
    v_mfma_f32_16x16x32_bf16 v[180:183], v[80:83], v[224:227], v[180:183]
    v_mfma_f32_16x16x32_bf16 v[184:187], v[164:167], v[224:227], v[184:187]
    v_mfma_f32_16x16x32_bf16 v[176:179], v[68:71], v[228:231], v[176:179]
    v_mfma_f32_16x16x32_bf16 v[180:183], v[84:87], v[228:231], v[180:183]
    v_mfma_f32_16x16x32_bf16 v[184:187], v[168:171], v[228:231], v[184:187]
    v_mfma_f32_16x16x32_bf16 v[116:119], v[28:31], a[36:39], v[116:119]
    ds_read_b128 v[20:23], v7 offset:19456
    v_mfma_f32_16x16x32_bf16 v[100:103], v[32:35], a[32:35], v[100:103]
    ds_read_b128 v[24:27], v7 offset:20480
    buffer_store_dwordx4 v[232:235], v237, s[12:15], s47 offen sc1
    v_mfma_f32_16x16x32_bf16 v[120:123], v[32:35], a[36:39], v[120:123]
    v_mfma_f32_16x16x32_bf16 v[104:107], v[36:39], a[32:35], v[104:107]
    v_mfma_f32_16x16x32_bf16 v[124:127], v[36:39], a[36:39], v[124:127]
    s_waitcnt lgkmcnt(0)
    v_mfma_f32_16x16x32_bf16 v[96:99], v[40:43], a[40:43], v[96:99]
    ds_read_b128 v[28:31], v7 offset:21504
    v_cvt_pk_bf16_f32 v176, v176, v177
    v_mfma_f32_16x16x32_bf16 v[116:119], v[40:43], a[44:47], v[116:119]
    ds_read_b128 v[32:35], v7 offset:22528
    v_cvt_pk_bf16_f32 v177, v178, v179
    v_mfma_f32_16x16x32_bf16 v[100:103], v[44:47], a[40:43], v[100:103]
    ds_read_b128 v[36:39], v7 offset:23552
    ds_write_b64 v248, v[176:177] offset:0
    v_mfma_f32_16x16x32_bf16 v[120:123], v[44:47], a[44:47], v[120:123]
    v_cvt_pk_bf16_f32 v180, v180, v181
    v_cvt_pk_bf16_f32 v181, v182, v183
    v_mfma_f32_16x16x32_bf16 v[104:107], v[48:51], a[40:43], v[104:107]
    ds_write_b64 v248, v[180:181] offset:32
    v_cvt_pk_bf16_f32 v184, v184, v185
    v_mfma_f32_16x16x32_bf16 v[124:127], v[48:51], a[44:47], v[124:127]
    v_cvt_pk_bf16_f32 v185, v186, v187
    ds_write_b64 v248, v[184:185] offset:64
    s_waitcnt lgkmcnt(6)
    s_waitcnt vmcnt(8)
    s_barrier
    v_mfma_f32_16x16x32_bf16 v[96:99], v[16:19], a[48:51], v[96:99]
    ds_read_b128 v[40:43], v7 offset:24576
    buffer_store_dwordx2 v[232:233], v238, s[12:15], s47 offen sc1
    v_mfma_f32_16x16x32_bf16 v[116:119], v[16:19], a[52:55], v[116:119]
    ds_read_b128 v[44:47], v7 offset:25600
    s_add_u32 m0, s65, 61440
    v_mfma_f32_16x16x32_bf16 v[100:103], v[20:23], a[48:51], v[100:103]
    ds_read_b128 v[48:51], v7 offset:26624
    v_mfma_f32_16x16x32_bf16 v[120:123], v[20:23], a[52:55], v[120:123]
    v_mfma_f32_16x16x32_bf16 v[104:107], v[24:27], a[48:51], v[104:107]
    buffer_load_dwordx4 v5, s[36:39], m0 offen lds
    s_add_u32 m0, s65, 62464
    v_mfma_f32_16x16x32_bf16 v[124:127], v[24:27], a[52:55], v[124:127]
    s_waitcnt lgkmcnt(0)
    s_barrier
    v_mfma_f32_16x16x32_bf16 v[96:99], v[28:31], a[56:59], v[96:99]
    ds_read_b128 v[16:19], v7 offset:27648
    ds_read_b128 v[176:179], v251
    v_mfma_f32_16x16x32_bf16 v[116:119], v[28:31], a[60:63], v[116:119]
    ds_read_b128 v[20:23], v7 offset:28672
    v_mfma_f32_16x16x32_bf16 v[100:103], v[32:35], a[56:59], v[100:103]
    ds_read_b128 v[24:27], v7 offset:29696
    buffer_load_dwordx4 v5, s[36:39], m0 offen lds
    v_mfma_f32_16x16x32_bf16 v[120:123], v[32:35], a[60:63], v[120:123]
    s_add_u32 m0, s65, 69632
    v_mfma_f32_16x16x32_bf16 v[104:107], v[36:39], a[56:59], v[104:107]
    v_mfma_f32_16x16x32_bf16 v[124:127], v[36:39], a[60:63], v[124:127]
    s_waitcnt lgkmcnt(0)
    v_mfma_f32_16x16x32_bf16 v[96:99], v[40:43], a[64:67], v[96:99]
    ds_read_b128 v[28:31], v7 offset:30720
    buffer_store_dwordx4 v[176:179], v250, s[12:15], s56 offen sc1
    v_mfma_f32_16x16x32_bf16 v[116:119], v[40:43], a[68:71], v[116:119]
    ds_read_b128 v[32:35], v7 offset:31744
    v_and_b32 v8, 1, v2
    v_mfma_f32_16x16x32_bf16 v[100:103], v[44:47], a[64:67], v[100:103]
    ds_read_b128 v[36:39], v7 offset:32768
    v_lshlrev_b32 v8, 4, v8
    v_mfma_f32_16x16x32_bf16 v[120:123], v[44:47], a[68:71], v[120:123]
    v_mov_b32 v12, 0x3f80
    v_lshlrev_b32 v8, v8, v12
    v_mfma_f32_16x16x32_bf16 v[104:107], v[48:51], a[64:67], v[104:107]
    v_lshrrev_b32 v12, 2, v2
    v_cmp_eq_u32 vcc, v12, v3
    s_nop 1
    v_cndmask_b32 v8, 0, v8, vcc
    v_mfma_f32_16x16x32_bf16 v[124:127], v[48:51], a[68:71], v[124:127]
    v_and_b32 v12, 2, v2
    v_cmp_eq_u32 vcc, 0, v12
    s_nop 1
    v_cndmask_b32 v210, 0, v8, vcc
    v_cndmask_b32 v211, v8, 0, vcc
    s_waitcnt lgkmcnt(3)
    v_mfma_f32_16x16x32_bf16 v[96:99], v[16:19], a[72:75], v[96:99]
    ds_read_b128 v[40:43], v7 offset:33792
    v_mov_b32 v208, 0
    v_mfma_f32_16x16x32_bf16 v[116:119], v[16:19], a[76:79], v[116:119]
    ds_read_b128 v[44:47], v7 offset:34816
    v_mov_b32 v209, 0
    v_mfma_f32_16x16x32_bf16 v[100:103], v[20:23], a[72:75], v[100:103]
    ds_read_b128 v[48:51], v7 offset:35840
    v_mov_b32 v212, 0
    v_mfma_f32_16x16x32_bf16 v[120:123], v[20:23], a[76:79], v[120:123]
    v_mov_b32 v213, 0
    buffer_load_dwordx4 v5, s[36:39], m0 offen lds
    v_mfma_f32_16x16x32_bf16 v[104:107], v[24:27], a[72:75], v[104:107]
    s_add_u32 m0, s65, 70656
    v_mfma_f32_16x16x32_bf16 v[124:127], v[24:27], a[76:79], v[124:127]
    s_waitcnt lgkmcnt(3)
    s_waitcnt vmcnt(10)
    s_barrier
    v_mfma_f32_16x16x32_bf16 v[96:99], v[28:31], a[80:83], v[96:99]
    ds_read_b128 v[16:19], v7 offset:36864
    v_mfma_f32_16x16x32_bf16 v[116:119], v[28:31], a[84:87], v[116:119]
    ds_read_b128 v[20:23], v7 offset:37888
    buffer_load_dwordx4 v5, s[36:39], m0 offen lds
    v_mfma_f32_16x16x32_bf16 v[100:103], v[32:35], a[80:83], v[100:103]
    ds_read_b128 v[24:27], v7 offset:38912
    s_add_u32 m0, s65, 77824
    v_mfma_f32_16x16x32_bf16 v[120:123], v[32:35], a[84:87], v[120:123]
    v_mfma_f32_16x16x32_bf16 v[104:107], v[36:39], a[80:83], v[104:107]
    v_mfma_f32_16x16x32_bf16 v[124:127], v[36:39], a[84:87], v[124:127]
    buffer_load_dwordx4 v5, s[36:39], m0 offen lds
    s_add_u32 m0, s65, 78848
    s_waitcnt lgkmcnt(3)
    v_mfma_f32_16x16x32_bf16 v[96:99], v[40:43], a[88:91], v[96:99]
    ds_read_b128 v[28:31], v7 offset:39936
    v_mfma_f32_16x16x32_bf16 v[116:119], v[40:43], a[92:95], v[116:119]
    ds_read_b128 v[32:35], v7 offset:40960
    v_mfma_f32_16x16x32_bf16 v[100:103], v[44:47], a[88:91], v[100:103]
    ds_read_b128 v[36:39], v7 offset:41984
    v_mfma_f32_16x16x32_bf16 v[120:123], v[44:47], a[92:95], v[120:123]
    buffer_load_dwordx4 v5, s[36:39], m0 offen lds
    s_add_u32 m0, s65, 86016
    v_mfma_f32_16x16x32_bf16 v[104:107], v[48:51], a[88:91], v[104:107]
    v_mfma_f32_16x16x32_bf16 v[124:127], v[48:51], a[92:95], v[124:127]
    s_waitcnt lgkmcnt(3)
    v_mfma_f32_16x16x32_bf16 v[96:99], v[16:19], a[96:99], v[96:99]
    ds_read_b128 v[40:43], v7 offset:43008
    v_mfma_f32_16x16x32_bf16 v[116:119], v[16:19], a[100:103], v[116:119]
    ds_read_b128 v[44:47], v7 offset:44032
    buffer_load_dwordx4 v5, s[36:39], m0 offen lds
    v_mfma_f32_16x16x32_bf16 v[100:103], v[20:23], a[96:99], v[100:103]
    ds_read_b128 v[48:51], v7 offset:45056
    s_add_u32 m0, s65, 87040
    v_mfma_f32_16x16x32_bf16 v[120:123], v[20:23], a[100:103], v[120:123]
    v_mfma_f32_16x16x32_bf16 v[104:107], v[24:27], a[96:99], v[104:107]
    v_mfma_f32_16x16x32_bf16 v[124:127], v[24:27], a[100:103], v[124:127]
    buffer_load_dwordx4 v5, s[36:39], m0 offen lds
    s_add_u32 m0, s65, 94208
    s_waitcnt lgkmcnt(3)
    v_mfma_f32_16x16x32_bf16 v[96:99], v[28:31], a[104:107], v[96:99]
    ds_read_b128 v[16:19], v7 offset:46080
    v_mfma_f32_16x16x32_bf16 v[116:119], v[28:31], a[108:111], v[116:119]
    ds_read_b128 v[20:23], v7 offset:47104
    v_mfma_f32_16x16x32_bf16 v[100:103], v[32:35], a[104:107], v[100:103]
    ds_read_b128 v[24:27], v7 offset:48128
    v_mfma_f32_16x16x32_bf16 v[120:123], v[32:35], a[108:111], v[120:123]
    buffer_load_dwordx4 v5, s[36:39], m0 offen lds
    s_add_u32 m0, s65, 95232
    v_mfma_f32_16x16x32_bf16 v[104:107], v[36:39], a[104:107], v[104:107]
    v_mfma_f32_16x16x32_bf16 v[124:127], v[36:39], a[108:111], v[124:127]
    s_waitcnt lgkmcnt(3)
    s_waitcnt vmcnt(13)
    s_barrier
    s_waitcnt vmcnt(8)
    s_barrier
    v_mfma_f32_16x16x32_bf16 v[96:99], v[40:43], a[112:115], v[96:99]
    ds_read_b128 v[28:31], v7 offset:49152
    v_mfma_f32_16x16x32_bf16 v[116:119], v[40:43], a[116:119], v[116:119]
    ds_read_b128 v[32:35], v7 offset:50176
    buffer_load_dwordx4 v5, s[36:39], m0 offen lds
    v_mfma_f32_16x16x32_bf16 v[100:103], v[44:47], a[112:115], v[100:103]
    ds_read_b128 v[36:39], v7 offset:51200
    v_mfma_f32_16x16x32_bf16 v[120:123], v[44:47], a[116:119], v[120:123]
    v_mfma_f32_16x16x32_bf16 v[104:107], v[48:51], a[112:115], v[104:107]
    v_mfma_f32_16x16x32_bf16 v[124:127], v[48:51], a[116:119], v[124:127]
    s_waitcnt lgkmcnt(3)
    v_mfma_f32_16x16x32_bf16 v[96:99], v[16:19], a[120:123], v[96:99]
    ds_read_b128 v[40:43], v7 offset:52224
    v_mfma_f32_16x16x32_bf16 v[116:119], v[16:19], a[124:127], v[116:119]
    ds_read_b128 v[44:47], v7 offset:53248
    v_mfma_f32_16x16x32_bf16 v[100:103], v[20:23], a[120:123], v[100:103]
    ds_read_b128 v[48:51], v7 offset:54272
    v_mfma_f32_16x16x32_bf16 v[120:123], v[20:23], a[124:127], v[120:123]
    v_mfma_f32_16x16x32_bf16 v[104:107], v[24:27], a[120:123], v[104:107]
    v_mfma_f32_16x16x32_bf16 v[124:127], v[24:27], a[124:127], v[124:127]
    s_waitcnt lgkmcnt(3)
    v_mfma_f32_16x16x32_bf16 v[96:99], v[28:31], a[128:131], v[96:99]
    ds_read_b128 v[16:19], v7 offset:55296
    v_mfma_f32_16x16x32_bf16 v[116:119], v[28:31], a[132:135], v[116:119]
    ds_read_b128 v[20:23], v7 offset:56320
    v_mfma_f32_16x16x32_bf16 v[100:103], v[32:35], a[128:131], v[100:103]
    ds_read_b128 v[24:27], v7 offset:57344
    v_mfma_f32_16x16x32_bf16 v[120:123], v[32:35], a[132:135], v[120:123]
    v_mfma_f32_16x16x32_bf16 v[104:107], v[36:39], a[128:131], v[104:107]
    v_mfma_f32_16x16x32_bf16 v[124:127], v[36:39], a[132:135], v[124:127]
    s_waitcnt lgkmcnt(3)
    s_barrier
    s_cmp_lg_u32 s18, 0
    s_cbranch_scc1 kA_sig1
    v_mov_b32 v240, 0
    v_mov_b32 v241, 1
    s_mov_b64 s[40:41], exec
    s_mov_b64 exec, 1
    buffer_atomic_add v241, v240, s[12:15], s45 offen sc1
    s_mov_b64 exec, s[40:41]
kA_sig1:
    v_mfma_f32_16x16x32_bf16 v[96:99], v[40:43], a[136:139], v[96:99]
    ds_read_b128 v[28:31], v7 offset:58368
    v_mfma_f32_16x16x32_bf16 v[116:119], v[40:43], a[140:143], v[116:119]
    ds_read_b128 v[32:35], v7 offset:59392
    v_mfma_f32_16x16x32_bf16 v[100:103], v[44:47], a[136:139], v[100:103]
    ds_read_b128 v[36:39], v7 offset:60416
    v_mfma_f32_16x16x32_bf16 v[120:123], v[44:47], a[140:143], v[120:123]
    v_mfma_f32_16x16x32_bf16 v[104:107], v[48:51], a[136:139], v[104:107]
    v_mfma_f32_16x16x32_bf16 v[124:127], v[48:51], a[140:143], v[124:127]
    s_waitcnt lgkmcnt(3)
    v_mfma_f32_16x16x32_bf16 v[96:99], v[16:19], a[144:147], v[96:99]
    v_mfma_f32_16x16x32_bf16 v[116:119], v[16:19], a[148:151], v[116:119]
    v_mfma_f32_16x16x32_bf16 v[100:103], v[20:23], a[144:147], v[100:103]
    ds_read_b128 v[40:43], v6 offset:0
    v_mfma_f32_16x16x32_bf16 v[120:123], v[20:23], a[148:151], v[120:123]
    ds_read_b128 v[44:47], v6 offset:1024
    v_mfma_f32_16x16x32_bf16 v[104:107], v[24:27], a[144:147], v[104:107]
    ds_read_b128 v[48:51], v6 offset:2048
    v_mfma_f32_16x16x32_bf16 v[124:127], v[24:27], a[148:151], v[124:127]
    ds_read_b128 v[52:55], v6 offset:3072
    s_waitcnt lgkmcnt(4)
    v_mfma_f32_16x16x32_bf16 v[96:99], v[28:31], a[152:155], v[96:99]
    v_mfma_f32_16x16x32_bf16 v[116:119], v[28:31], a[156:159], v[116:119]
    v_mfma_f32_16x16x32_bf16 v[100:103], v[32:35], a[152:155], v[100:103]
    v_mfma_f32_16x16x32_bf16 v[120:123], v[32:35], a[156:159], v[120:123]
    ds_read_b128 v[16:19], v6 offset:4096
    v_mfma_f32_16x16x32_bf16 v[104:107], v[36:39], a[152:155], v[104:107]
    ds_read_b128 v[20:23], v6 offset:5120
    v_mfma_f32_16x16x32_bf16 v[124:127], v[36:39], a[156:159], v[124:127]
    s_waitcnt lgkmcnt(2)
    v_mfma_f32_16x16x32_bf16 v[108:111], v[40:43], a[0:3], 0
    ds_read_b128 v[24:27], v6 offset:6144
    v_max3_f32 v200, v96, v97, v98
    v_mfma_f32_16x16x32_bf16 v[128:131], v[40:43], a[4:7], 0
    ds_read_b128 v[28:31], v6 offset:7168
    v_min3_f32 v202, v96, v97, v98
    v_mfma_f32_16x16x32_bf16 v[112:115], v[44:47], a[0:3], 0
    v_max3_f32 v201, v116, v117, v118
    v_min3_f32 v203, v116, v117, v118
    v_mfma_f32_16x16x32_bf16 v[132:135], v[44:47], a[4:7], 0
    v_max3_f32 v200, v200, v99, v100
    v_min3_f32 v202, v202, v99, v100
    s_waitcnt vmcnt(6)
    s_barrier
    v_mfma_f32_16x16x32_bf16 v[108:111], v[48:51], a[8:11], v[108:111]
    ds_read_b128 v[40:43], v6 offset:8192
    s_add_u32 m0, s21, 102400
    v_mfma_f32_16x16x32_bf16 v[128:131], v[48:51], a[12:15], v[128:131]
    ds_read_b128 v[44:47], v6 offset:9216
    buffer_load_dwordx4 v5, s[48:51], m0 offen lds
    v_mfma_f32_16x16x32_bf16 v[112:115], v[52:55], a[8:11], v[112:115]
    s_add_u32 m0, s21, 106496
    v_max3_f32 v201, v201, v119, v120
    v_mfma_f32_16x16x32_bf16 v[132:135], v[52:55], a[12:15], v[132:135]
    v_min3_f32 v203, v203, v119, v120
    v_max3_f32 v200, v200, v101, v102
    s_waitcnt lgkmcnt(2)
    v_mfma_f32_16x16x32_bf16 v[108:111], v[16:19], a[16:19], v[108:111]
    ds_read_b128 v[48:51], v6 offset:10240
    v_min3_f32 v202, v202, v101, v102
    v_mfma_f32_16x16x32_bf16 v[128:131], v[16:19], a[20:23], v[128:131]
    ds_read_b128 v[52:55], v6 offset:11264
    buffer_load_dwordx4 v5, s[48:51], m0 offen lds
    v_mfma_f32_16x16x32_bf16 v[112:115], v[20:23], a[16:19], v[112:115]
    s_add_u32 m0, s21, 110592
    v_max3_f32 v201, v201, v121, v122
    v_mfma_f32_16x16x32_bf16 v[132:135], v[20:23], a[20:23], v[132:135]
    v_min3_f32 v203, v203, v121, v122
    v_max3_f32 v200, v200, v103, v104
    v_mfma_f32_16x16x32_bf16 v[108:111], v[24:27], a[24:27], v[108:111]
    ds_read_b128 v[16:19], v6 offset:12288
    v_min3_f32 v202, v202, v103, v104
    v_mfma_f32_16x16x32_bf16 v[128:131], v[24:27], a[28:31], v[128:131]
    ds_read_b128 v[20:23], v6 offset:13312
    buffer_load_dwordx4 v5, s[48:51], m0 offen lds
    v_mfma_f32_16x16x32_bf16 v[112:115], v[28:31], a[24:27], v[112:115]
    s_add_u32 m0, s21, 114688
    v_max3_f32 v201, v201, v123, v124
    v_mfma_f32_16x16x32_bf16 v[132:135], v[28:31], a[28:31], v[132:135]
    v_min3_f32 v203, v203, v123, v124
    v_max_f32 v200, v200, v105
    s_waitcnt lgkmcnt(2)
    v_mfma_f32_16x16x32_bf16 v[108:111], v[40:43], a[32:35], v[108:111]
    ds_read_b128 v[24:27], v6 offset:14336
    v_min_f32 v202, v202, v105
    v_mfma_f32_16x16x32_bf16 v[128:131], v[40:43], a[36:39], v[128:131]
    ds_read_b128 v[28:31], v6 offset:15360
    buffer_load_dwordx4 v5, s[48:51], m0 offen lds
    v_mfma_f32_16x16x32_bf16 v[112:115], v[44:47], a[32:35], v[112:115]
    s_add_u32 m0, s21, 118784
    v_max_f32 v201, v201, v125
    v_mfma_f32_16x16x32_bf16 v[132:135], v[44:47], a[36:39], v[132:135]
    v_min_f32 v203, v203, v125
    v_permlane16_swap_b32 v200, v201
    s_waitcnt vmcnt(8)
    s_barrier
    v_mfma_f32_16x16x32_bf16 v[108:111], v[48:51], a[40:43], v[108:111]
    ds_read_b128 v[40:43], v6 offset:16384
    v_mfma_f32_16x16x32_bf16 v[128:131], v[48:51], a[44:47], v[128:131]
    ds_read_b128 v[44:47], v6 offset:17408
    buffer_load_dwordx4 v5, s[48:51], m0 offen lds
    v_mfma_f32_16x16x32_bf16 v[112:115], v[52:55], a[40:43], v[112:115]
    s_add_u32 m0, s21, 122880
    v_permlane16_swap_b32 v202, v203
    v_mfma_f32_16x16x32_bf16 v[132:135], v[52:55], a[44:47], v[132:135]
    v_max_f32 v200, v200, v201
    s_waitcnt lgkmcnt(2)
    v_mfma_f32_16x16x32_bf16 v[108:111], v[16:19], a[48:51], v[108:111]
    ds_read_b128 v[48:51], v6 offset:18432
    buffer_load_dwordx4 v5, s[48:51], m0 offen lds
    v_mfma_f32_16x16x32_bf16 v[128:131], v[16:19], a[52:55], v[128:131]
    ds_read_b128 v[52:55], v6 offset:19456
    v_min_f32 v202, v202, v203
    v_mfma_f32_16x16x32_bf16 v[112:115], v[20:23], a[48:51], v[112:115]
    v_mov_b32 v201, v200
    v_mov_b32 v203, v202
    v_mfma_f32_16x16x32_bf16 v[132:135], v[20:23], a[52:55], v[132:135]
    buffer_load_dwordx4 v[56:59], v250, s[12:15], s61 offen sc1
    s_add_u32 s61, s61, 4096
    v_mfma_f32_16x16x32_bf16 v[108:111], v[24:27], a[56:59], v[108:111]
    ds_read_b128 v[16:19], v6 offset:20480
    v_permlane16_swap_b32 v200, v201
    v_mfma_f32_16x16x32_bf16 v[128:131], v[24:27], a[60:63], v[128:131]
    ds_read_b128 v[20:23], v6 offset:21504
    v_mfma_f32_16x16x32_bf16 v[112:115], v[28:31], a[56:59], v[112:115]
    buffer_load_dwordx4 v[60:63], v250, s[12:15], s61 offen sc1
    s_add_u32 s61, s61, 4096
    v_mfma_f32_16x16x32_bf16 v[132:135], v[28:31], a[60:63], v[132:135]
    v_permlane16_swap_b32 v202, v203
    s_waitcnt lgkmcnt(2)
    v_mfma_f32_16x16x32_bf16 v[108:111], v[40:43], a[64:67], v[108:111]
    ds_read_b128 v[24:27], v6 offset:22528
    v_mul_f32 v200, v14, v200
    v_mfma_f32_16x16x32_bf16 v[128:131], v[40:43], a[68:71], v[128:131]
    ds_read_b128 v[28:31], v6 offset:23552
    buffer_load_dwordx4 v[64:67], v250, s[12:15], s61 offen sc1
    v_mfma_f32_16x16x32_bf16 v[112:115], v[44:47], a[64:67], v[112:115]
    s_add_u32 s61, s61, 4096
    v_mul_f32 v202, v14, v202
    v_mfma_f32_16x16x32_bf16 v[132:135], v[44:47], a[68:71], v[132:135]
    v_mul_f32 v201, v15, v201
    v_mul_f32 v203, v15, v203
    s_waitcnt vmcnt(11)
    s_barrier
    v_mfma_f32_16x16x32_bf16 v[108:111], v[48:51], a[72:75], v[108:111]
    ds_read_b128 v[40:43], v6 offset:24576
    buffer_load_dwordx4 v[68:71], v250, s[12:15], s61 offen sc1
    v_mfma_f32_16x16x32_bf16 v[128:131], v[48:51], a[76:79], v[128:131]
    ds_read_b128 v[44:47], v6 offset:25600
    s_add_u32 s61, s61, 4096
    v_mfma_f32_16x16x32_bf16 v[112:115], v[52:55], a[72:75], v[112:115]
    v_fma_f32 v156, v96, v14, -v200
    v_fma_f32 v96, -v96, v14, v202
    v_mfma_f32_16x16x32_bf16 v[132:135], v[52:55], a[76:79], v[132:135]
    buffer_load_dwordx4 v[72:75], v250, s[12:15], s61 offen sc1
    s_add_u32 s61, s61, 4096
    s_waitcnt lgkmcnt(2)
    v_mfma_f32_16x16x32_bf16 v[108:111], v[16:19], a[80:83], v[108:111]
    ds_read_b128 v[48:51], v6 offset:26624
    v_fma_f32 v166, v116, v15, -v201
    v_mfma_f32_16x16x32_bf16 v[128:131], v[16:19], a[84:87], v[128:131]
    ds_read_b128 v[52:55], v6 offset:27648
    v_fma_f32 v116, -v116, v15, v203
    v_mfma_f32_16x16x32_bf16 v[112:115], v[20:23], a[80:83], v[112:115]
    buffer_load_dwordx4 v[76:79], v250, s[12:15], s61 offen sc1
    s_add_u32 s61, s61, 4096
    v_mfma_f32_16x16x32_bf16 v[132:135], v[20:23], a[84:87], v[132:135]
    v_fma_f32 v157, v97, v14, -v200
    v_fma_f32 v97, -v97, v14, v202
    v_mfma_f32_16x16x32_bf16 v[108:111], v[24:27], a[88:91], v[108:111]
    ds_read_b128 v[16:19], v6 offset:28672
    v_exp_f32 v156, v156
    v_mfma_f32_16x16x32_bf16 v[128:131], v[24:27], a[92:95], v[128:131]
    ds_read_b128 v[20:23], v6 offset:29696
    v_mfma_f32_16x16x32_bf16 v[112:115], v[28:31], a[88:91], v[112:115]
    buffer_load_dwordx4 v[80:83], v250, s[12:15], s61 offen sc1
    s_add_u32 s61, s61, 4096
    v_mfma_f32_16x16x32_bf16 v[132:135], v[28:31], a[92:95], v[132:135]
    v_exp_f32 v96, v96
    s_waitcnt lgkmcnt(2)
    v_mfma_f32_16x16x32_bf16 v[108:111], v[40:43], a[96:99], v[108:111]
    ds_read_b128 v[24:27], v6 offset:30720
    v_fma_f32 v167, v117, v15, -v201
    v_mfma_f32_16x16x32_bf16 v[128:131], v[40:43], a[100:103], v[128:131]
    ds_read_b128 v[28:31], v6 offset:31744
    buffer_load_dwordx4 v[84:87], v250, s[12:15], s61 offen sc1
    v_mfma_f32_16x16x32_bf16 v[112:115], v[44:47], a[96:99], v[112:115]
    s_add_u32 s61, s61, 4096
    v_fma_f32 v117, -v117, v15, v203
    v_mfma_f32_16x16x32_bf16 v[132:135], v[44:47], a[100:103], v[132:135]
    v_exp_f32 v166, v166
    s_waitcnt vmcnt(14)
    s_barrier
    v_mfma_f32_16x16x32_bf16 v[108:111], v[48:51], a[104:107], v[108:111]
    ds_read_b128 v[40:43], v6 offset:32768
    buffer_load_dwordx4 v[88:91], v250, s[12:15], s61 offen sc1
    v_mfma_f32_16x16x32_bf16 v[128:131], v[48:51], a[108:111], v[128:131]
    ds_read_b128 v[44:47], v6 offset:33792
    s_add_u32 s61, s61, 4096
    v_mfma_f32_16x16x32_bf16 v[112:115], v[52:55], a[104:107], v[112:115]
    v_exp_f32 v116, v116
    v_mfma_f32_16x16x32_bf16 v[132:135], v[52:55], a[108:111], v[132:135]
    buffer_load_dwordx4 v[92:95], v250, s[12:15], s61 offen sc1
    s_add_u32 s61, s61, 4096
    s_waitcnt lgkmcnt(2)
    v_mfma_f32_16x16x32_bf16 v[108:111], v[16:19], a[112:115], v[108:111]
    ds_read_b128 v[48:51], v6 offset:34816
    v_fma_f32 v158, v98, v14, -v200
    v_mfma_f32_16x16x32_bf16 v[128:131], v[16:19], a[116:119], v[128:131]
    ds_read_b128 v[52:55], v6 offset:35840
    v_fma_f32 v98, -v98, v14, v202
    v_mfma_f32_16x16x32_bf16 v[112:115], v[20:23], a[112:115], v[112:115]
    buffer_load_dwordx4 v[216:219], v250, s[12:15], s61 offen sc1
    s_add_u32 s61, s61, 4096
    v_mfma_f32_16x16x32_bf16 v[132:135], v[20:23], a[116:119], v[132:135]
    v_exp_f32 v157, v157
    v_mfma_f32_16x16x32_bf16 v[108:111], v[24:27], a[120:123], v[108:111]
    ds_read_b128 v[16:19], v6 offset:36864
    v_exp_f32 v97, v97
    v_mfma_f32_16x16x32_bf16 v[128:131], v[24:27], a[124:127], v[128:131]
    ds_read_b128 v[20:23], v6 offset:37888
    v_mfma_f32_16x16x32_bf16 v[112:115], v[28:31], a[120:123], v[112:115]
    buffer_load_dwordx4 v[220:223], v250, s[12:15], s61 offen sc1
    s_add_u32 s61, s61, 4096
    v_mfma_f32_16x16x32_bf16 v[132:135], v[28:31], a[124:127], v[132:135]
    v_fma_f32 v168, v118, v15, -v201
    v_fma_f32 v118, -v118, v15, v203
    s_waitcnt lgkmcnt(2)
    v_mfma_f32_16x16x32_bf16 v[108:111], v[40:43], a[128:131], v[108:111]
    ds_read_b128 v[24:27], v6 offset:38912
    v_exp_f32 v167, v167
    v_mfma_f32_16x16x32_bf16 v[128:131], v[40:43], a[132:135], v[128:131]
    ds_read_b128 v[28:31], v6 offset:39936
    v_mfma_f32_16x16x32_bf16 v[112:115], v[44:47], a[128:131], v[112:115]
    buffer_load_dwordx4 v[224:227], v250, s[12:15], s61 offen sc1
    s_add_u32 s61, s61, 4096
    v_mfma_f32_16x16x32_bf16 v[132:135], v[44:47], a[132:135], v[132:135]
    v_exp_f32 v117, v117
    v_mfma_f32_16x16x32_bf16 v[108:111], v[48:51], a[136:139], v[108:111]
    v_fma_f32 v159, v99, v14, -v200
    v_fma_f32 v99, -v99, v14, v202
    v_mfma_f32_16x16x32_bf16 v[128:131], v[48:51], a[140:143], v[128:131]
    buffer_load_dwordx4 v[228:231], v250, s[12:15], s61 offen sc1
    s_add_u32 s61, s61, 4096
    v_mfma_f32_16x16x32_bf16 v[112:115], v[52:55], a[136:139], v[112:115]
    v_exp_f32 v158, v158
    v_mfma_f32_16x16x32_bf16 v[132:135], v[52:55], a[140:143], v[132:135]
    v_exp_f32 v98, v98
    s_waitcnt lgkmcnt(0)
    v_mfma_f32_16x16x32_bf16 v[108:111], v[16:19], a[144:147], v[108:111]
    buffer_load_dwordx4 v[136:139], v250, s[12:15], s61 offen sc1
    s_add_u32 s61, s61, 4096
    v_mfma_f32_16x16x32_bf16 v[128:131], v[16:19], a[148:151], v[128:131]
    v_add_f32 v204, v156, v157
    v_add_f32 v206, v96, v97
    v_mfma_f32_16x16x32_bf16 v[112:115], v[20:23], a[144:147], v[112:115]
    v_fma_f32 v169, v119, v15, -v201
    v_fma_f32 v119, -v119, v15, v203
    v_mfma_f32_16x16x32_bf16 v[132:135], v[20:23], a[148:151], v[132:135]
    buffer_load_dwordx4 v[140:143], v250, s[12:15], s61 offen sc1
    s_add_u32 m0, s21, 126976
    v_mfma_f32_16x16x32_bf16 v[108:111], v[24:27], a[152:155], v[108:111]
    v_exp_f32 v168, v168
    v_mfma_f32_16x16x32_bf16 v[128:131], v[24:27], a[156:159], v[128:131]
    v_exp_f32 v118, v118
    v_mfma_f32_16x16x32_bf16 v[112:115], v[28:31], a[152:155], v[112:115]
    buffer_load_dwordx4 v5, s[48:51], m0 offen lds
    s_add_u32 m0, s21, 131072
    v_mfma_f32_16x16x32_bf16 v[132:135], v[28:31], a[156:159], v[132:135]
    v_add_f32 v205, v166, v167
    v_add_f32 v207, v116, v117
    v_fma_f32 v160, v100, v14, -v200
    v_fma_f32 v100, -v100, v14, v202
    v_exp_f32 v159, v159
    v_exp_f32 v99, v99
    v_add_f32 v204, v204, v158
    v_add_f32 v206, v206, v98
    s_waitcnt vmcnt(13)
    v_mfma_f32_16x16x32_bf16 v[144:147], v[210:213], v[56:59], 0
    v_fma_f32 v170, v120, v15, -v201
    v_fma_f32 v120, -v120, v15, v203
    buffer_load_dwordx4 v5, s[48:51], m0 offen lds
    v_exp_f32 v169, v169
    v_mfma_f32_16x16x32_bf16 v[148:151], v[208:211], v[56:59], 0
    v_exp_f32 v119, v119
    v_add_f32 v205, v205, v168
    v_add_f32 v207, v207, v118
    v_mfma_f32_16x16x32_bf16 v[144:147], v[210:213], v[60:63], v[144:147]
    v_fma_f32 v161, v101, v14, -v200
    v_fma_f32 v101, -v101, v14, v202
    v_exp_f32 v160, v160
    v_mfma_f32_16x16x32_bf16 v[148:151], v[208:211], v[60:63], v[148:151]
    v_exp_f32 v100, v100
    s_add_u32 m0, s21, 135168
    s_nop 0
    buffer_load_dwordx4 v5, s[48:51], m0 offen lds
    v_add_f32 v204, v204, v159
    v_add_f32 v206, v206, v99
    v_mfma_f32_16x16x32_bf16 v[144:147], v[210:213], v[64:67], v[144:147]
    v_fma_f32 v171, v121, v15, -v201
    v_fma_f32 v121, -v121, v15, v203
    v_exp_f32 v170, v170
    v_mfma_f32_16x16x32_bf16 v[148:151], v[208:211], v[64:67], v[148:151]
    v_exp_f32 v120, v120
    v_add_f32 v205, v205, v169
    v_add_f32 v207, v207, v119
    s_add_u32 m0, s21, 139264
    s_nop 0
    buffer_load_dwordx4 v5, s[48:51], m0 offen lds
    v_mfma_f32_16x16x32_bf16 v[144:147], v[210:213], v[68:71], v[144:147]
    v_fma_f32 v162, v102, v14, -v200
    v_fma_f32 v102, -v102, v14, v202
    v_exp_f32 v161, v161
    v_mfma_f32_16x16x32_bf16 v[148:151], v[208:211], v[68:71], v[148:151]
    v_exp_f32 v101, v101
    v_add_f32 v204, v204, v160
    v_add_f32 v206, v206, v100
    v_fma_f32 v172, v122, v15, -v201
    v_fma_f32 v122, -v122, v15, v203
    s_add_u32 m0, s21, 143360
    s_nop 0
    buffer_load_dwordx4 v5, s[48:51], m0 offen lds
    v_exp_f32 v171, v171
    v_exp_f32 v121, v121
    v_add_f32 v205, v205, v170
    v_add_f32 v207, v207, v120
    s_waitcnt vmcnt(13)
    v_mfma_f32_16x16x32_bf16 v[144:147], v[210:213], v[72:75], v[144:147]
    v_fma_f32 v163, v103, v14, -v200
    v_fma_f32 v103, -v103, v14, v202
    v_exp_f32 v162, v162
    v_mfma_f32_16x16x32_bf16 v[148:151], v[208:211], v[72:75], v[148:151]
    v_exp_f32 v102, v102
    s_add_u32 m0, s21, 147456
    s_nop 0
    buffer_load_dwordx4 v5, s[48:51], m0 offen lds
    v_add_f32 v204, v204, v161
    v_add_f32 v206, v206, v101
    v_mfma_f32_16x16x32_bf16 v[144:147], v[210:213], v[76:79], v[144:147]
    v_fma_f32 v173, v123, v15, -v201
    v_fma_f32 v123, -v123, v15, v203
    v_exp_f32 v172, v172
    v_mfma_f32_16x16x32_bf16 v[148:151], v[208:211], v[76:79], v[148:151]
    v_exp_f32 v122, v122
    v_add_f32 v205, v205, v171
    v_add_f32 v207, v207, v121
    s_add_u32 m0, s21, 151552
    s_nop 0
    buffer_load_dwordx4 v5, s[48:51], m0 offen lds
    v_mfma_f32_16x16x32_bf16 v[144:147], v[210:213], v[80:83], v[144:147]
    v_fma_f32 v164, v104, v14, -v200
    v_fma_f32 v104, -v104, v14, v202
    v_exp_f32 v163, v163
    v_mfma_f32_16x16x32_bf16 v[148:151], v[208:211], v[80:83], v[148:151]
    v_exp_f32 v103, v103
    v_add_f32 v204, v204, v162
    v_add_f32 v206, v206, v102
    v_mfma_f32_16x16x32_bf16 v[144:147], v[210:213], v[84:87], v[144:147]
    v_fma_f32 v174, v124, v15, -v201
    v_fma_f32 v124, -v124, v15, v203
    s_add_u32 m0, s21, 155648
    s_nop 0
    buffer_load_dwordx4 v5, s[48:51], m0 offen lds
    v_exp_f32 v173, v173
    v_mfma_f32_16x16x32_bf16 v[148:151], v[208:211], v[84:87], v[148:151]
    v_exp_f32 v123, v123
    v_add_f32 v205, v205, v172
    v_add_f32 v207, v207, v122
    v_fma_f32 v165, v105, v14, -v200
    v_fma_f32 v105, -v105, v14, v202
    v_exp_f32 v164, v164
    v_exp_f32 v104, v104
    s_add_u32 m0, s21, 159744
    s_nop 0
    buffer_load_dwordx4 v5, s[48:51], m0 offen lds
    v_add_f32 v204, v204, v163
    v_add_f32 v206, v206, v103
    s_waitcnt vmcnt(13)
    v_mfma_f32_16x16x32_bf16 v[144:147], v[210:213], v[88:91], v[144:147]
    v_fma_f32 v175, v125, v15, -v201
    v_fma_f32 v125, -v125, v15, v203
    v_exp_f32 v174, v174
    v_mfma_f32_16x16x32_bf16 v[148:151], v[208:211], v[88:91], v[148:151]
    v_exp_f32 v124, v124
    v_add_f32 v205, v205, v173
    v_add_f32 v207, v207, v123
    v_mfma_f32_16x16x32_bf16 v[144:147], v[210:213], v[92:95], v[144:147]
    v_exp_f32 v165, v165
    v_exp_f32 v105, v105
    v_add_f32 v204, v204, v164
    v_mfma_f32_16x16x32_bf16 v[148:151], v[208:211], v[92:95], v[148:151]
    v_add_f32 v206, v206, v104
    v_exp_f32 v175, v175
    v_exp_f32 v125, v125
    v_mfma_f32_16x16x32_bf16 v[144:147], v[210:213], v[216:219], v[144:147]
    v_add_f32 v205, v205, v174
    v_add_f32 v207, v207, v124
    v_add_f32 v204, v204, v165
    v_mfma_f32_16x16x32_bf16 v[148:151], v[208:211], v[216:219], v[148:151]
    v_add_f32 v206, v206, v105
    v_add_f32 v205, v205, v175
    v_add_f32 v207, v207, v125
    v_mfma_f32_16x16x32_bf16 v[144:147], v[210:213], v[220:223], v[144:147]
    v_permlane16_swap_b32 v204, v205
    v_permlane16_swap_b32 v206, v207
    v_add_f32 v204, v204, v205
    v_mfma_f32_16x16x32_bf16 v[148:151], v[208:211], v[220:223], v[148:151]
    v_add_f32 v206, v206, v207
    v_rcp_f32 v206, v206
    v_mov_b32 v205, v204
    v_mul_f32 v206, v204, v206
    v_mov_b32 v207, v206
    v_permlane16_swap_b32 v204, v205
    s_nop 0
    v_permlane16_swap_b32 v206, v207
    v_mul_f32 v96, v206, v96
    v_mul_f32 v97, v206, v97
    s_waitcnt vmcnt(9)
    v_mfma_f32_16x16x32_bf16 v[144:147], v[210:213], v[224:227], v[144:147]
    v_mul_f32 v98, v206, v98
    v_mul_f32 v99, v206, v99
    v_mul_f32 v100, v206, v100
    v_mfma_f32_16x16x32_bf16 v[148:151], v[208:211], v[224:227], v[148:151]
    v_mul_f32 v101, v206, v101
    v_mul_f32 v102, v206, v102
    v_mul_f32 v103, v206, v103
    v_mfma_f32_16x16x32_bf16 v[144:147], v[210:213], v[228:231], v[144:147]
    v_mul_f32 v104, v206, v104
    v_mul_f32 v105, v206, v105
    v_cvt_pk_bf16_f32 v176, v156, v157
    v_mfma_f32_16x16x32_bf16 v[148:151], v[208:211], v[228:231], v[148:151]
    v_cvt_pk_bf16_f32 v181, v96, v97
    v_cvt_pk_bf16_f32 v177, v158, v159
    v_cvt_pk_bf16_f32 v182, v98, v99
    v_mfma_f32_16x16x32_bf16 v[144:147], v[210:213], v[136:139], v[144:147]
    v_cvt_pk_bf16_f32 v178, v160, v161
    v_cvt_pk_bf16_f32 v183, v100, v101
    v_cvt_pk_bf16_f32 v179, v162, v163
    v_mfma_f32_16x16x32_bf16 v[148:151], v[208:211], v[136:139], v[148:151]
    v_cvt_pk_bf16_f32 v184, v102, v103
    v_cvt_pk_bf16_f32 v180, v164, v165
    v_cvt_pk_bf16_f32 v185, v104, v105
    v_mfma_f32_16x16x32_bf16 v[144:147], v[210:213], v[140:143], v[144:147]
    v_mov_b32 v186, 0
    v_mov_b32 v187, 0
    v_mul_f32 v116, v207, v116
    v_mfma_f32_16x16x32_bf16 v[148:151], v[208:211], v[140:143], v[148:151]
    v_mul_f32 v117, v207, v117
    v_mul_f32 v118, v207, v118
    v_mul_f32 v119, v207, v119
    v_mul_f32 v120, v207, v120
    v_mul_f32 v121, v207, v121
    v_mul_f32 v122, v207, v122
    v_mul_f32 v123, v207, v123
    v_mul_f32 v124, v207, v124
    v_mul_f32 v125, v207, v125
    v_cvt_pk_bf16_f32 v188, v166, v167
    v_cvt_pk_bf16_f32 v193, v116, v117
    v_cvt_pk_bf16_f32 v189, v168, v169
    v_cvt_pk_bf16_f32 v194, v118, v119
    v_cvt_pk_bf16_f32 v190, v170, v171
    v_cvt_pk_bf16_f32 v195, v120, v121
    v_cvt_pk_bf16_f32 v191, v172, v173
    v_cvt_pk_bf16_f32 v196, v122, v123
    v_cvt_pk_bf16_f32 v192, v174, v175
    v_cvt_pk_bf16_f32 v197, v124, v125
    v_mov_b32 v198, 0
    v_mov_b32 v199, 0
    v_cmp_u_f32 vcc, v144, v148
    s_cbranch_vccnz kA_kn
kA_knd:
    v_cvt_pk_bf16_f32 v208, v144, v145
    v_cvt_pk_bf16_f32 v209, v146, v147
    v_cvt_pk_bf16_f32 v210, v148, v149
    v_cvt_pk_bf16_f32 v211, v150, v151
    v_cmp_gt_u32 vcc, 252, v0
    s_nop 0
    s_and_saveexec_b64 s[40:41], vcc
    ds_write_b128 v252, v[208:211]
    s_mov_b64 exec, s[40:41]
    s_add_u32 s3, s46, 13926400
    buffer_load_dwordx4 v[224:227], v236, s[12:15], s3 offen
    buffer_load_dwordx4 v[228:231], v237, s[12:15], s3 offen
    buffer_load_dwordx2 v[232:233], v238, s[12:15], s3 offen
    v_and_b32 v234, 15, v1
    v_lshlrev_b32 v234, 7, v234
    s_mov_b32 s47, 4997120
    buffer_load_dword v235, v234, s[12:15], s47 offen sc1
    s_waitcnt lgkmcnt(0)
    s_barrier
    ds_read_b128 v[40:43], v249 offset:0
    ds_read_b128 v[44:47], v249 offset:16
    ds_read_b128 v[48:51], v249 offset:32
    ds_read_b128 v[16:19], v253 offset:0
    ds_read_b128 v[20:23], v253 offset:16
    ds_read_b128 v[24:27], v253 offset:32
    ds_read_b128 v[28:31], v253 offset:384
    ds_read_b128 v[32:35], v253 offset:400
    ds_read_b128 v[36:39], v253 offset:416
    s_add_u32 s3, s46, 6062080
    s_waitcnt lgkmcnt(6)
    v_mfma_f32_16x16x32_bf16 v[64:67], v[40:43], v[176:179], 0
    v_mfma_f32_16x16x32_bf16 v[64:67], v[44:47], v[180:183], v[64:67]
    v_mfma_f32_16x16x32_bf16 v[64:67], v[48:51], v[184:187], v[64:67]
    s_waitcnt lgkmcnt(3)
    v_mfma_f32_16x16x32_bf16 v[56:59], v[16:19], v[176:179], 0
    v_mfma_f32_16x16x32_bf16 v[56:59], v[20:23], v[180:183], v[56:59]
    v_mfma_f32_16x16x32_bf16 v[56:59], v[24:27], v[184:187], v[56:59]
    s_waitcnt lgkmcnt(0)
    v_mfma_f32_16x16x32_bf16 v[60:63], v[28:31], v[176:179], 0
    v_mfma_f32_16x16x32_bf16 v[60:63], v[32:35], v[180:183], v[60:63]
    v_mfma_f32_16x16x32_bf16 v[60:63], v[36:39], v[184:187], v[60:63]
    v_mfma_f32_16x16x32_bf16 v[76:79], v[40:43], v[188:191], 0
    v_mfma_f32_16x16x32_bf16 v[76:79], v[44:47], v[192:195], v[76:79]
    v_fmac_f32 v66, 0x358637bd, v204
    v_rcp_f32 v80, v66
    v_mfma_f32_16x16x32_bf16 v[76:79], v[48:51], v[196:199], v[76:79]
    v_mul_f32 v56, v80, v56
    v_mul_f32 v57, v80, v57
    v_mfma_f32_16x16x32_bf16 v[68:71], v[16:19], v[188:191], 0
    v_mul_f32 v58, v80, v58
    v_mul_f32 v59, v80, v59
    v_mfma_f32_16x16x32_bf16 v[68:71], v[20:23], v[192:195], v[68:71]
    v_mul_f32 v60, v80, v60
    v_mul_f32 v61, v80, v61
    v_fmac_f32 v78, 0x358637bd, v205
    v_rcp_f32 v81, v78
    v_mfma_f32_16x16x32_bf16 v[68:71], v[24:27], v[196:199], v[68:71]
    v_mul_f32 v62, v80, v62
    v_mul_f32 v63, v80, v63
    v_mfma_f32_16x16x32_bf16 v[72:75], v[28:31], v[188:191], 0
    v_mul_f32 v64, v80, v64
    v_mul_f32 v65, v80, v65
    v_mfma_f32_16x16x32_bf16 v[72:75], v[32:35], v[192:195], v[72:75]
    v_cvt_pk_bf16_f32 v156, v56, v57
    v_cvt_pk_bf16_f32 v157, v58, v59
    v_mfma_f32_16x16x32_bf16 v[72:75], v[36:39], v[196:199], v[72:75]
    v_cvt_pk_bf16_f32 v158, v60, v61
    v_cvt_pk_bf16_f32 v159, v62, v63
    v_cvt_pk_bf16_f32 v164, v64, v65
    buffer_store_dwordx4 v[156:159], v236, s[12:15], s3 offen sc1
    v_mul_f32 v68, v81, v68
    v_mul_f32 v69, v81, v69
    v_mul_f32 v70, v81, v70
    v_mul_f32 v71, v81, v71
    v_mul_f32 v72, v81, v72
    v_mul_f32 v73, v81, v73
    v_mul_f32 v74, v81, v74
    v_mul_f32 v75, v81, v75
    v_mul_f32 v76, v81, v76
    v_mul_f32 v77, v81, v77
    v_cvt_pk_bf16_f32 v160, v68, v69
    v_cvt_pk_bf16_f32 v161, v70, v71
    v_cvt_pk_bf16_f32 v162, v72, v73
    v_cvt_pk_bf16_f32 v163, v74, v75
    v_cvt_pk_bf16_f32 v165, v76, v77
    buffer_store_dwordx4 v[160:163], v237, s[12:15], s3 offen sc1
    s_nop 0
    v_permlane16_swap_b32 v164, v165
    buffer_store_dwordx2 v[164:165], v238, s[12:15], s3 offen sc1
    s_waitcnt vmcnt(3)
    v_permlane16_swap_b32 v232, v233
    v_lshlrev_b32 v96, 16, v224
    v_and_b32 v97, 0xffff0000, v224
    v_lshlrev_b32 v98, 16, v225
    v_and_b32 v99, 0xffff0000, v225
    v_lshlrev_b32 v100, 16, v226
    v_and_b32 v101, 0xffff0000, v226
    v_lshlrev_b32 v102, 16, v227
    v_and_b32 v103, 0xffff0000, v227
    v_lshlrev_b32 v104, 16, v232
    v_and_b32 v105, 0xffff0000, v232
    v_lshlrev_b32 v116, 16, v228
    v_and_b32 v117, 0xffff0000, v228
    v_lshlrev_b32 v118, 16, v229
    v_and_b32 v119, 0xffff0000, v229
    v_lshlrev_b32 v120, 16, v230
    v_and_b32 v121, 0xffff0000, v230
    v_lshlrev_b32 v122, 16, v231
    v_and_b32 v123, 0xffff0000, v231
    v_lshlrev_b32 v124, 16, v233
    v_and_b32 v125, 0xffff0000, v233
    s_waitcnt vmcnt(3)
    s_barrier
    v_cmp_gt_u32 vcc, 16, v235
    s_cbranch_vccnz kA_gw
kA_gwd:
    s_add_u32 m0, s21, 61440
    s_nop 0
    buffer_load_dwordx4 v5, s[52:55], m0 offen lds
    s_add_u32 m0, s21, 65536
    s_nop 0
    buffer_load_dwordx4 v5, s[52:55], m0 offen lds
    s_add_u32 m0, s21, 69632
    s_nop 0
    buffer_load_dwordx4 v5, s[52:55], m0 offen lds
    s_add_u32 m0, s21, 73728
    s_nop 0
    buffer_load_dwordx4 v5, s[52:55], m0 offen lds
    s_add_u32 m0, s21, 77824
    s_nop 0
    buffer_load_dwordx4 v5, s[52:55], m0 offen lds
    s_add_u32 m0, s21, 81920
    s_nop 0
    buffer_load_dwordx4 v5, s[52:55], m0 offen lds
    s_add_u32 m0, s21, 86016
    s_nop 0
    buffer_load_dwordx4 v5, s[52:55], m0 offen lds
    s_add_u32 m0, s21, 90112
    s_nop 0
    buffer_load_dwordx4 v5, s[52:55], m0 offen lds
    s_add_u32 m0, s21, 94208
    s_nop 0
    buffer_load_dwordx4 v5, s[52:55], m0 offen lds
    s_add_u32 m0, s21, 98304
    s_nop 0
    buffer_load_dwordx4 v5, s[52:55], m0 offen lds
    s_add_u32 s19, s44, 6062080
    s_add_u32 s4, s12, s19
    s_addc_u32 s5, s13, 0
    s_mov_b32 s33, 0
kA_t5:
    s_mov_b32 s20, 0
    s_mov_b32 s35, 20480
    buffer_load_dwordx4 a[0:3], v5, s[4:7], s20 offen offset:0 sc1
    buffer_load_dwordx4 a[4:7], v5, s[4:7], s35 offen offset:0 sc1
    buffer_load_dwordx4 a[8:11], v5, s[4:7], s20 offen offset:1024 sc1
    buffer_load_dwordx4 a[12:15], v5, s[4:7], s35 offen offset:1024 sc1
    buffer_load_dwordx4 a[16:19], v5, s[4:7], s20 offen offset:2048 sc1
    buffer_load_dwordx4 a[20:23], v5, s[4:7], s35 offen offset:2048 sc1
    buffer_load_dwordx4 a[24:27], v5, s[4:7], s20 offen offset:3072 sc1
    buffer_load_dwordx4 a[28:31], v5, s[4:7], s35 offen offset:3072 sc1
    s_add_u32 s20, s20, 4096
    s_add_u32 s35, s35, 4096
    buffer_load_dwordx4 a[32:35], v5, s[4:7], s20 offen offset:0 sc1
    buffer_load_dwordx4 a[36:39], v5, s[4:7], s35 offen offset:0 sc1
    buffer_load_dwordx4 a[40:43], v5, s[4:7], s20 offen offset:1024 sc1
    buffer_load_dwordx4 a[44:47], v5, s[4:7], s35 offen offset:1024 sc1
    ds_read_b128 v[16:19], v7 offset:0
    ds_read_b128 v[20:23], v7 offset:1024
    ds_read_b128 v[24:27], v7 offset:2048
    ds_read_b128 v[28:31], v7 offset:3072
    ds_read_b128 v[32:35], v7 offset:4096
    s_waitcnt vmcnt(10)
    v_accvgpr_read_b32 v8, a0
    v_accvgpr_read_b32 v9, a2
    v_accvgpr_read_b32 v10, a4
    v_accvgpr_read_b32 v11, a6
    v_max_u32 v8, v8, v9
    v_max3_u32 v8, v8, v10, v11
    v_cmp_eq_u32 vcc, -1, v8
    s_cbranch_vccnz kA_rt0
kA_c0:
    s_waitcnt lgkmcnt(0)
    v_mfma_f32_16x16x32_bf16 v[56:59], v[16:19], a[0:3], v[96:99]
    ds_read_b128 v[36:39], v7 offset:5120
    buffer_load_dwordx4 a[48:51], v5, s[4:7], s20 offen offset:2048 sc1
    v_mfma_f32_16x16x32_bf16 v[76:79], v[16:19], a[4:7], v[116:119]
    ds_read_b128 v[40:43], v7 offset:6144
    v_mfma_f32_16x16x32_bf16 v[60:63], v[20:23], a[0:3], v[100:103]
    ds_read_b128 v[44:47], v7 offset:7168
    v_mfma_f32_16x16x32_bf16 v[80:83], v[20:23], a[4:7], v[120:123]
    ds_read_b128 v[48:51], v7 offset:8192
    v_mfma_f32_16x16x32_bf16 v[64:67], v[24:27], a[0:3], v[104:107]
    s_waitcnt vmcnt(9)
    ds_read_b128 v[52:55], v7 offset:9216
    v_accvgpr_read_b32 v8, a8
    v_mfma_f32_16x16x32_bf16 v[84:87], v[24:27], a[4:7], v[124:127]
    v_accvgpr_read_b32 v9, a10
    v_accvgpr_read_b32 v10, a12
    v_mfma_f32_16x16x32_bf16 v[68:71], v[28:31], a[0:3], v[108:111]
    v_accvgpr_read_b32 v11, a14
    v_max_u32 v8, v8, v9
    v_mfma_f32_16x16x32_bf16 v[88:91], v[28:31], a[4:7], v[128:131]
    v_max3_u32 v8, v8, v10, v11
    v_cmp_eq_u32 vcc, -1, v8
    v_mfma_f32_16x16x32_bf16 v[72:75], v[32:35], a[0:3], v[112:115]
    buffer_load_dwordx4 a[52:55], v5, s[4:7], s35 offen offset:2048 sc1
    v_mfma_f32_16x16x32_bf16 v[92:95], v[32:35], a[4:7], v[132:135]
    s_waitcnt lgkmcnt(0)
    s_cbranch_vccnz kA_rt1
kA_c1:
    v_mfma_f32_16x16x32_bf16 v[56:59], v[36:39], a[8:11], v[56:59]
    ds_read_b128 v[16:19], v7 offset:10240
    v_mfma_f32_16x16x32_bf16 v[76:79], v[36:39], a[12:15], v[76:79]
    ds_read_b128 v[20:23], v7 offset:11264
    v_mfma_f32_16x16x32_bf16 v[60:63], v[40:43], a[8:11], v[60:63]
    ds_read_b128 v[24:27], v7 offset:12288
    buffer_load_dwordx4 a[56:59], v5, s[4:7], s20 offen offset:3072 sc1
    v_mfma_f32_16x16x32_bf16 v[80:83], v[40:43], a[12:15], v[80:83]
    ds_read_b128 v[28:31], v7 offset:13312
    v_mfma_f32_16x16x32_bf16 v[64:67], v[44:47], a[8:11], v[64:67]
    s_waitcnt vmcnt(9)
    ds_read_b128 v[32:35], v7 offset:14336
    v_accvgpr_read_b32 v8, a16
    v_mfma_f32_16x16x32_bf16 v[84:87], v[44:47], a[12:15], v[84:87]
    v_accvgpr_read_b32 v9, a18
    v_accvgpr_read_b32 v10, a20
    v_mfma_f32_16x16x32_bf16 v[68:71], v[48:51], a[8:11], v[68:71]
    v_accvgpr_read_b32 v11, a22
    v_max_u32 v8, v8, v9
    v_mfma_f32_16x16x32_bf16 v[88:91], v[48:51], a[12:15], v[88:91]
    v_max3_u32 v8, v8, v10, v11
    v_cmp_eq_u32 vcc, -1, v8
    v_mfma_f32_16x16x32_bf16 v[72:75], v[52:55], a[8:11], v[72:75]
    buffer_load_dwordx4 a[60:63], v5, s[4:7], s35 offen offset:3072 sc1
    s_add_u32 s20, s20, 4096
    v_mfma_f32_16x16x32_bf16 v[92:95], v[52:55], a[12:15], v[92:95]
    s_add_u32 s35, s35, 4096
    s_waitcnt lgkmcnt(0)
    s_cbranch_vccnz kA_rt2
kA_c2:
    v_mfma_f32_16x16x32_bf16 v[56:59], v[16:19], a[16:19], v[56:59]
    ds_read_b128 v[36:39], v7 offset:15360
    v_mfma_f32_16x16x32_bf16 v[76:79], v[16:19], a[20:23], v[76:79]
    ds_read_b128 v[40:43], v7 offset:16384
    v_mfma_f32_16x16x32_bf16 v[60:63], v[20:23], a[16:19], v[60:63]
    ds_read_b128 v[44:47], v7 offset:17408
    buffer_load_dwordx4 a[64:67], v5, s[4:7], s20 offen offset:0 sc1
    v_mfma_f32_16x16x32_bf16 v[80:83], v[20:23], a[20:23], v[80:83]
    ds_read_b128 v[48:51], v7 offset:18432
    v_mfma_f32_16x16x32_bf16 v[64:67], v[24:27], a[16:19], v[64:67]
    s_waitcnt vmcnt(9)
    ds_read_b128 v[52:55], v7 offset:19456
    v_accvgpr_read_b32 v8, a24
    v_mfma_f32_16x16x32_bf16 v[84:87], v[24:27], a[20:23], v[84:87]
    v_accvgpr_read_b32 v9, a26
    v_accvgpr_read_b32 v10, a28
    v_mfma_f32_16x16x32_bf16 v[68:71], v[28:31], a[16:19], v[68:71]
    v_accvgpr_read_b32 v11, a30
    v_max_u32 v8, v8, v9
    v_mfma_f32_16x16x32_bf16 v[88:91], v[28:31], a[20:23], v[88:91]
    v_max3_u32 v8, v8, v10, v11
    v_cmp_eq_u32 vcc, -1, v8
    v_mfma_f32_16x16x32_bf16 v[72:75], v[32:35], a[16:19], v[72:75]
    buffer_load_dwordx4 a[68:71], v5, s[4:7], s35 offen offset:0 sc1
    v_mfma_f32_16x16x32_bf16 v[92:95], v[32:35], a[20:23], v[92:95]
    s_waitcnt lgkmcnt(0)
    s_cbranch_vccnz kA_rt3
kA_c3:
    v_mfma_f32_16x16x32_bf16 v[56:59], v[36:39], a[24:27], v[56:59]
    ds_read_b128 v[16:19], v7 offset:20480
    v_mfma_f32_16x16x32_bf16 v[76:79], v[36:39], a[28:31], v[76:79]
    ds_read_b128 v[20:23], v7 offset:21504
    v_mfma_f32_16x16x32_bf16 v[60:63], v[40:43], a[24:27], v[60:63]
    ds_read_b128 v[24:27], v7 offset:22528
    buffer_load_dwordx4 a[72:75], v5, s[4:7], s20 offen offset:1024 sc1
    v_mfma_f32_16x16x32_bf16 v[80:83], v[40:43], a[28:31], v[80:83]
    ds_read_b128 v[28:31], v7 offset:23552
    v_mfma_f32_16x16x32_bf16 v[64:67], v[44:47], a[24:27], v[64:67]
    s_waitcnt vmcnt(9)
    ds_read_b128 v[32:35], v7 offset:24576
    v_accvgpr_read_b32 v8, a32
    v_mfma_f32_16x16x32_bf16 v[84:87], v[44:47], a[28:31], v[84:87]
    v_accvgpr_read_b32 v9, a34
    v_accvgpr_read_b32 v10, a36
    v_mfma_f32_16x16x32_bf16 v[68:71], v[48:51], a[24:27], v[68:71]
    v_accvgpr_read_b32 v11, a38
    v_max_u32 v8, v8, v9
    v_mfma_f32_16x16x32_bf16 v[88:91], v[48:51], a[28:31], v[88:91]
    v_max3_u32 v8, v8, v10, v11
    v_cmp_eq_u32 vcc, -1, v8
    v_mfma_f32_16x16x32_bf16 v[72:75], v[52:55], a[24:27], v[72:75]
    buffer_load_dwordx4 a[76:79], v5, s[4:7], s35 offen offset:1024 sc1
    v_mfma_f32_16x16x32_bf16 v[92:95], v[52:55], a[28:31], v[92:95]
    s_waitcnt lgkmcnt(0)
    s_cbranch_vccnz kA_rt4
kA_c4:
    v_mfma_f32_16x16x32_bf16 v[56:59], v[16:19], a[32:35], v[56:59]
    ds_read_b128 v[36:39], v7 offset:25600
    v_mfma_f32_16x16x32_bf16 v[76:79], v[16:19], a[36:39], v[76:79]
    ds_read_b128 v[40:43], v7 offset:26624
    v_mfma_f32_16x16x32_bf16 v[60:63], v[20:23], a[32:35], v[60:63]
    ds_read_b128 v[44:47], v7 offset:27648
    buffer_load_dwordx4 a[80:83], v5, s[4:7], s20 offen offset:2048 sc1
    v_mfma_f32_16x16x32_bf16 v[80:83], v[20:23], a[36:39], v[80:83]
    ds_read_b128 v[48:51], v7 offset:28672
    v_mfma_f32_16x16x32_bf16 v[64:67], v[24:27], a[32:35], v[64:67]
    s_waitcnt vmcnt(9)
    ds_read_b128 v[52:55], v7 offset:29696
    v_accvgpr_read_b32 v8, a40
    v_mfma_f32_16x16x32_bf16 v[84:87], v[24:27], a[36:39], v[84:87]
    v_accvgpr_read_b32 v9, a42
    v_accvgpr_read_b32 v10, a44
    v_mfma_f32_16x16x32_bf16 v[68:71], v[28:31], a[32:35], v[68:71]
    v_accvgpr_read_b32 v11, a46
    v_max_u32 v8, v8, v9
    v_mfma_f32_16x16x32_bf16 v[88:91], v[28:31], a[36:39], v[88:91]
    v_max3_u32 v8, v8, v10, v11
    v_cmp_eq_u32 vcc, -1, v8
    v_mfma_f32_16x16x32_bf16 v[72:75], v[32:35], a[32:35], v[72:75]
    buffer_load_dwordx4 a[84:87], v5, s[4:7], s35 offen offset:2048 sc1
    v_mfma_f32_16x16x32_bf16 v[92:95], v[32:35], a[36:39], v[92:95]
    s_waitcnt lgkmcnt(0)
    s_cbranch_vccnz kA_rt5
kA_c5:
    v_mfma_f32_16x16x32_bf16 v[56:59], v[36:39], a[40:43], v[56:59]
    ds_read_b128 v[16:19], v7 offset:30720
    v_mfma_f32_16x16x32_bf16 v[76:79], v[36:39], a[44:47], v[76:79]
    ds_read_b128 v[20:23], v7 offset:31744
    v_mfma_f32_16x16x32_bf16 v[60:63], v[40:43], a[40:43], v[60:63]
    ds_read_b128 v[24:27], v7 offset:32768
    buffer_load_dwordx4 a[88:91], v5, s[4:7], s20 offen offset:3072 sc1
    v_mfma_f32_16x16x32_bf16 v[80:83], v[40:43], a[44:47], v[80:83]
    ds_read_b128 v[28:31], v7 offset:33792
    v_mfma_f32_16x16x32_bf16 v[64:67], v[44:47], a[40:43], v[64:67]
    s_waitcnt vmcnt(9)
    ds_read_b128 v[32:35], v7 offset:34816
    v_mfma_f32_16x16x32_bf16 v[84:87], v[44:47], a[44:47], v[84:87]
    v_mfma_f32_16x16x32_bf16 v[68:71], v[48:51], a[40:43], v[68:71]
    buffer_load_dwordx4 a[92:95], v5, s[4:7], s35 offen offset:3072 sc1
    s_add_u32 s20, s20, 4096
    v_mfma_f32_16x16x32_bf16 v[88:91], v[48:51], a[44:47], v[88:91]
    s_add_u32 s35, s35, 4096
    v_mfma_f32_16x16x32_bf16 v[72:75], v[52:55], a[40:43], v[72:75]
    v_mfma_f32_16x16x32_bf16 v[92:95], v[52:55], a[44:47], v[92:95]
    s_waitcnt lgkmcnt(0)
    v_mfma_f32_16x16x32_bf16 v[56:59], v[16:19], a[48:51], v[56:59]
    ds_read_b128 v[36:39], v7 offset:35840
    buffer_load_dwordx4 a[96:99], v5, s[4:7], s20 offen offset:0 sc1
    v_mfma_f32_16x16x32_bf16 v[76:79], v[16:19], a[52:55], v[76:79]
    ds_read_b128 v[40:43], v7 offset:36864
    v_mfma_f32_16x16x32_bf16 v[60:63], v[20:23], a[48:51], v[60:63]
    ds_read_b128 v[44:47], v7 offset:37888
    v_mfma_f32_16x16x32_bf16 v[80:83], v[20:23], a[52:55], v[80:83]
    ds_read_b128 v[48:51], v7 offset:38912
    v_mfma_f32_16x16x32_bf16 v[64:67], v[24:27], a[48:51], v[64:67]
    s_waitcnt vmcnt(9)
    ds_read_b128 v[52:55], v7 offset:39936
    buffer_load_dwordx4 a[100:103], v5, s[4:7], s35 offen offset:0 sc1
    v_mfma_f32_16x16x32_bf16 v[84:87], v[24:27], a[52:55], v[84:87]
    v_mfma_f32_16x16x32_bf16 v[68:71], v[28:31], a[48:51], v[68:71]
    v_mfma_f32_16x16x32_bf16 v[88:91], v[28:31], a[52:55], v[88:91]
    v_mfma_f32_16x16x32_bf16 v[72:75], v[32:35], a[48:51], v[72:75]
    buffer_load_dwordx4 a[104:107], v5, s[4:7], s20 offen offset:1024 sc1
    v_mfma_f32_16x16x32_bf16 v[92:95], v[32:35], a[52:55], v[92:95]
    s_waitcnt lgkmcnt(0)
    v_mfma_f32_16x16x32_bf16 v[56:59], v[36:39], a[56:59], v[56:59]
    ds_read_b128 v[16:19], v7 offset:40960
    v_mfma_f32_16x16x32_bf16 v[76:79], v[36:39], a[60:63], v[76:79]
    ds_read_b128 v[20:23], v7 offset:41984
    v_mfma_f32_16x16x32_bf16 v[60:63], v[40:43], a[56:59], v[60:63]
    ds_read_b128 v[24:27], v7 offset:43008
    buffer_load_dwordx4 a[108:111], v5, s[4:7], s35 offen offset:1024 sc1
    v_mfma_f32_16x16x32_bf16 v[80:83], v[40:43], a[60:63], v[80:83]
    ds_read_b128 v[28:31], v7 offset:44032
    v_mfma_f32_16x16x32_bf16 v[64:67], v[44:47], a[56:59], v[64:67]
    s_waitcnt vmcnt(10)
    ds_read_b128 v[32:35], v7 offset:45056
    v_mfma_f32_16x16x32_bf16 v[84:87], v[44:47], a[60:63], v[84:87]
    v_mfma_f32_16x16x32_bf16 v[68:71], v[48:51], a[56:59], v[68:71]
    buffer_load_dwordx4 a[112:115], v5, s[4:7], s20 offen offset:2048 sc1
    v_mfma_f32_16x16x32_bf16 v[88:91], v[48:51], a[60:63], v[88:91]
    v_mfma_f32_16x16x32_bf16 v[72:75], v[52:55], a[56:59], v[72:75]
    v_mfma_f32_16x16x32_bf16 v[92:95], v[52:55], a[60:63], v[92:95]
    s_waitcnt lgkmcnt(0)
    v_mfma_f32_16x16x32_bf16 v[56:59], v[16:19], a[64:67], v[56:59]
    ds_read_b128 v[36:39], v7 offset:46080
    buffer_load_dwordx4 a[116:119], v5, s[4:7], s35 offen offset:2048 sc1
    v_mfma_f32_16x16x32_bf16 v[76:79], v[16:19], a[68:71], v[76:79]
    ds_read_b128 v[40:43], v7 offset:47104
    v_mfma_f32_16x16x32_bf16 v[60:63], v[20:23], a[64:67], v[60:63]
    ds_read_b128 v[44:47], v7 offset:48128
    v_mfma_f32_16x16x32_bf16 v[80:83], v[20:23], a[68:71], v[80:83]
    ds_read_b128 v[48:51], v7 offset:49152
    v_mfma_f32_16x16x32_bf16 v[64:67], v[24:27], a[64:67], v[64:67]
    s_waitcnt vmcnt(10)
    ds_read_b128 v[52:55], v7 offset:50176
    buffer_load_dwordx4 a[120:123], v5, s[4:7], s20 offen offset:3072 sc1
    v_mfma_f32_16x16x32_bf16 v[84:87], v[24:27], a[68:71], v[84:87]
    v_mfma_f32_16x16x32_bf16 v[68:71], v[28:31], a[64:67], v[68:71]
    v_mfma_f32_16x16x32_bf16 v[88:91], v[28:31], a[68:71], v[88:91]
    v_mfma_f32_16x16x32_bf16 v[72:75], v[32:35], a[64:67], v[72:75]
    buffer_load_dwordx4 a[124:127], v5, s[4:7], s35 offen offset:3072 sc1
    s_add_u32 s20, s20, 4096
    v_mfma_f32_16x16x32_bf16 v[92:95], v[32:35], a[68:71], v[92:95]
    s_add_u32 s35, s35, 4096
    s_waitcnt lgkmcnt(0)
    v_mfma_f32_16x16x32_bf16 v[56:59], v[36:39], a[72:75], v[56:59]
    ds_read_b128 v[16:19], v7 offset:51200
    v_mfma_f32_16x16x32_bf16 v[76:79], v[36:39], a[76:79], v[76:79]
    ds_read_b128 v[20:23], v7 offset:52224
    v_mfma_f32_16x16x32_bf16 v[60:63], v[40:43], a[72:75], v[60:63]
    ds_read_b128 v[24:27], v7 offset:53248
    buffer_load_dwordx4 a[128:131], v5, s[4:7], s20 offen offset:0 sc1
    v_mfma_f32_16x16x32_bf16 v[80:83], v[40:43], a[76:79], v[80:83]
    ds_read_b128 v[28:31], v7 offset:54272
    v_mfma_f32_16x16x32_bf16 v[64:67], v[44:47], a[72:75], v[64:67]
    s_waitcnt vmcnt(11)
    ds_read_b128 v[32:35], v7 offset:55296
    v_mfma_f32_16x16x32_bf16 v[84:87], v[44:47], a[76:79], v[84:87]
    v_mfma_f32_16x16x32_bf16 v[68:71], v[48:51], a[72:75], v[68:71]
    buffer_load_dwordx4 a[132:135], v5, s[4:7], s35 offen offset:0 sc1
    v_mfma_f32_16x16x32_bf16 v[88:91], v[48:51], a[76:79], v[88:91]
    v_mfma_f32_16x16x32_bf16 v[72:75], v[52:55], a[72:75], v[72:75]
    v_mfma_f32_16x16x32_bf16 v[92:95], v[52:55], a[76:79], v[92:95]
    s_waitcnt lgkmcnt(0)
    v_mfma_f32_16x16x32_bf16 v[56:59], v[16:19], a[80:83], v[56:59]
    ds_read_b128 v[36:39], v7 offset:56320
    buffer_load_dwordx4 a[136:139], v5, s[4:7], s20 offen offset:1024 sc1
    v_mfma_f32_16x16x32_bf16 v[76:79], v[16:19], a[84:87], v[76:79]
    ds_read_b128 v[40:43], v7 offset:57344
    v_mfma_f32_16x16x32_bf16 v[60:63], v[20:23], a[80:83], v[60:63]
    ds_read_b128 v[44:47], v7 offset:58368
    v_mfma_f32_16x16x32_bf16 v[80:83], v[20:23], a[84:87], v[80:83]
    ds_read_b128 v[48:51], v7 offset:59392
    v_mfma_f32_16x16x32_bf16 v[64:67], v[24:27], a[80:83], v[64:67]
    s_waitcnt vmcnt(11)
    ds_read_b128 v[52:55], v7 offset:60416
    buffer_load_dwordx4 a[140:143], v5, s[4:7], s35 offen offset:1024 sc1
    v_mfma_f32_16x16x32_bf16 v[84:87], v[24:27], a[84:87], v[84:87]
    v_mfma_f32_16x16x32_bf16 v[68:71], v[28:31], a[80:83], v[68:71]
    v_mfma_f32_16x16x32_bf16 v[88:91], v[28:31], a[84:87], v[88:91]
    v_mfma_f32_16x16x32_bf16 v[72:75], v[32:35], a[80:83], v[72:75]
    buffer_load_dwordx4 a[144:147], v5, s[4:7], s20 offen offset:2048 sc1
    v_mfma_f32_16x16x32_bf16 v[92:95], v[32:35], a[84:87], v[92:95]
    s_waitcnt lgkmcnt(0)
    s_cmp_lg_u32 s33, 0
    s_cbranch_scc1 kA_nob
    s_barrier
kA_nob:
    v_mfma_f32_16x16x32_bf16 v[56:59], v[36:39], a[88:91], v[56:59]
    ds_read_b128 v[16:19], v6 offset:0
    v_mfma_f32_16x16x32_bf16 v[76:79], v[36:39], a[92:95], v[76:79]
    ds_read_b128 v[20:23], v6 offset:1024
    v_mfma_f32_16x16x32_bf16 v[60:63], v[40:43], a[88:91], v[60:63]
    ds_read_b128 v[24:27], v6 offset:2048
    buffer_load_dwordx4 a[148:151], v5, s[4:7], s35 offen offset:2048 sc1
    v_mfma_f32_16x16x32_bf16 v[80:83], v[40:43], a[92:95], v[80:83]
    ds_read_b128 v[28:31], v6 offset:3072
    v_mfma_f32_16x16x32_bf16 v[64:67], v[44:47], a[88:91], v[64:67]
    s_waitcnt vmcnt(12)
    ds_read_b128 v[32:35], v6 offset:4096
    v_mfma_f32_16x16x32_bf16 v[84:87], v[44:47], a[92:95], v[84:87]
    v_mfma_f32_16x16x32_bf16 v[68:71], v[48:51], a[88:91], v[68:71]
    buffer_load_dwordx4 a[152:155], v5, s[4:7], s20 offen offset:3072 sc1
    v_mfma_f32_16x16x32_bf16 v[88:91], v[48:51], a[92:95], v[88:91]
    v_mfma_f32_16x16x32_bf16 v[72:75], v[52:55], a[88:91], v[72:75]
    v_mfma_f32_16x16x32_bf16 v[92:95], v[52:55], a[92:95], v[92:95]
    s_waitcnt lgkmcnt(0)
    v_mfma_f32_16x16x32_bf16 v[56:59], v[16:19], a[96:99], v[56:59]
    ds_read_b128 v[36:39], v6 offset:5120
    buffer_load_dwordx4 a[156:159], v5, s[4:7], s35 offen offset:3072 sc1
    v_mfma_f32_16x16x32_bf16 v[76:79], v[16:19], a[100:103], v[76:79]
    ds_read_b128 v[40:43], v6 offset:6144
    v_mfma_f32_16x16x32_bf16 v[60:63], v[20:23], a[96:99], v[60:63]
    ds_read_b128 v[44:47], v6 offset:7168
    v_mfma_f32_16x16x32_bf16 v[80:83], v[20:23], a[100:103], v[80:83]
    ds_read_b128 v[48:51], v6 offset:8192
    v_mfma_f32_16x16x32_bf16 v[64:67], v[24:27], a[96:99], v[64:67]
    s_waitcnt vmcnt(12)
    ds_read_b128 v[52:55], v6 offset:9216
    v_mfma_f32_16x16x32_bf16 v[84:87], v[24:27], a[100:103], v[84:87]
    v_mfma_f32_16x16x32_bf16 v[68:71], v[28:31], a[96:99], v[68:71]
    v_mfma_f32_16x16x32_bf16 v[88:91], v[28:31], a[100:103], v[88:91]
    v_mfma_f32_16x16x32_bf16 v[72:75], v[32:35], a[96:99], v[72:75]
    v_mfma_f32_16x16x32_bf16 v[92:95], v[32:35], a[100:103], v[92:95]
    s_waitcnt lgkmcnt(0)
    v_mfma_f32_16x16x32_bf16 v[56:59], v[36:39], a[104:107], v[56:59]
    ds_read_b128 v[16:19], v6 offset:10240
    v_mfma_f32_16x16x32_bf16 v[76:79], v[36:39], a[108:111], v[76:79]
    ds_read_b128 v[20:23], v6 offset:11264
    v_mfma_f32_16x16x32_bf16 v[60:63], v[40:43], a[104:107], v[60:63]
    ds_read_b128 v[24:27], v6 offset:12288
    v_mfma_f32_16x16x32_bf16 v[80:83], v[40:43], a[108:111], v[80:83]
    ds_read_b128 v[28:31], v6 offset:13312
    v_mfma_f32_16x16x32_bf16 v[64:67], v[44:47], a[104:107], v[64:67]
    s_waitcnt vmcnt(10)
    ds_read_b128 v[32:35], v6 offset:14336
    v_mfma_f32_16x16x32_bf16 v[84:87], v[44:47], a[108:111], v[84:87]
    v_mfma_f32_16x16x32_bf16 v[68:71], v[48:51], a[104:107], v[68:71]
    v_mfma_f32_16x16x32_bf16 v[88:91], v[48:51], a[108:111], v[88:91]
    v_mfma_f32_16x16x32_bf16 v[72:75], v[52:55], a[104:107], v[72:75]
    v_mfma_f32_16x16x32_bf16 v[92:95], v[52:55], a[108:111], v[92:95]
    s_waitcnt lgkmcnt(0)
    v_mfma_f32_16x16x32_bf16 v[56:59], v[16:19], a[112:115], v[56:59]
    ds_read_b128 v[36:39], v6 offset:15360
    v_mfma_f32_16x16x32_bf16 v[76:79], v[16:19], a[116:119], v[76:79]
    ds_read_b128 v[40:43], v6 offset:16384
    v_mfma_f32_16x16x32_bf16 v[60:63], v[20:23], a[112:115], v[60:63]
    ds_read_b128 v[44:47], v6 offset:17408
    v_mfma_f32_16x16x32_bf16 v[80:83], v[20:23], a[116:119], v[80:83]
    ds_read_b128 v[48:51], v6 offset:18432
    v_mfma_f32_16x16x32_bf16 v[64:67], v[24:27], a[112:115], v[64:67]
    s_waitcnt vmcnt(8)
    ds_read_b128 v[52:55], v6 offset:19456
    v_mfma_f32_16x16x32_bf16 v[84:87], v[24:27], a[116:119], v[84:87]
    v_mfma_f32_16x16x32_bf16 v[68:71], v[28:31], a[112:115], v[68:71]
    v_mfma_f32_16x16x32_bf16 v[88:91], v[28:31], a[116:119], v[88:91]
    v_mfma_f32_16x16x32_bf16 v[72:75], v[32:35], a[112:115], v[72:75]
    v_mfma_f32_16x16x32_bf16 v[92:95], v[32:35], a[116:119], v[92:95]
    s_waitcnt lgkmcnt(0)
    v_mfma_f32_16x16x32_bf16 v[56:59], v[36:39], a[120:123], v[56:59]
    ds_read_b128 v[16:19], v6 offset:20480
    v_mfma_f32_16x16x32_bf16 v[76:79], v[36:39], a[124:127], v[76:79]
    ds_read_b128 v[20:23], v6 offset:21504
    v_mfma_f32_16x16x32_bf16 v[60:63], v[40:43], a[120:123], v[60:63]
    ds_read_b128 v[24:27], v6 offset:22528
    v_mfma_f32_16x16x32_bf16 v[80:83], v[40:43], a[124:127], v[80:83]
    ds_read_b128 v[28:31], v6 offset:23552
    v_mfma_f32_16x16x32_bf16 v[64:67], v[44:47], a[120:123], v[64:67]
    s_waitcnt vmcnt(6)
    ds_read_b128 v[32:35], v6 offset:24576
    v_mfma_f32_16x16x32_bf16 v[84:87], v[44:47], a[124:127], v[84:87]
    v_mfma_f32_16x16x32_bf16 v[68:71], v[48:51], a[120:123], v[68:71]
    v_mfma_f32_16x16x32_bf16 v[88:91], v[48:51], a[124:127], v[88:91]
    v_mfma_f32_16x16x32_bf16 v[72:75], v[52:55], a[120:123], v[72:75]
    v_mfma_f32_16x16x32_bf16 v[92:95], v[52:55], a[124:127], v[92:95]
    s_waitcnt lgkmcnt(0)
    v_mfma_f32_16x16x32_bf16 v[56:59], v[16:19], a[128:131], v[56:59]
    ds_read_b128 v[36:39], v6 offset:25600
    v_mfma_f32_16x16x32_bf16 v[76:79], v[16:19], a[132:135], v[76:79]
    ds_read_b128 v[40:43], v6 offset:26624
    v_mfma_f32_16x16x32_bf16 v[60:63], v[20:23], a[128:131], v[60:63]
    ds_read_b128 v[44:47], v6 offset:27648
    v_mfma_f32_16x16x32_bf16 v[80:83], v[20:23], a[132:135], v[80:83]
    ds_read_b128 v[48:51], v6 offset:28672
    v_mfma_f32_16x16x32_bf16 v[64:67], v[24:27], a[128:131], v[64:67]
    s_waitcnt vmcnt(4)
    ds_read_b128 v[52:55], v6 offset:29696
    v_mfma_f32_16x16x32_bf16 v[84:87], v[24:27], a[132:135], v[84:87]
    v_mfma_f32_16x16x32_bf16 v[68:71], v[28:31], a[128:131], v[68:71]
    v_mfma_f32_16x16x32_bf16 v[88:91], v[28:31], a[132:135], v[88:91]
    v_mfma_f32_16x16x32_bf16 v[72:75], v[32:35], a[128:131], v[72:75]
    v_mfma_f32_16x16x32_bf16 v[92:95], v[32:35], a[132:135], v[92:95]
    s_waitcnt lgkmcnt(0)
    v_mfma_f32_16x16x32_bf16 v[56:59], v[36:39], a[136:139], v[56:59]
    ds_read_b128 v[16:19], v6 offset:30720
    v_mfma_f32_16x16x32_bf16 v[76:79], v[36:39], a[140:143], v[76:79]
    ds_read_b128 v[20:23], v6 offset:31744
    v_mfma_f32_16x16x32_bf16 v[60:63], v[40:43], a[136:139], v[60:63]
    ds_read_b128 v[24:27], v6 offset:32768
    v_mfma_f32_16x16x32_bf16 v[80:83], v[40:43], a[140:143], v[80:83]
    ds_read_b128 v[28:31], v6 offset:33792
    v_mfma_f32_16x16x32_bf16 v[64:67], v[44:47], a[136:139], v[64:67]
    s_waitcnt vmcnt(2)
    ds_read_b128 v[32:35], v6 offset:34816
    v_mfma_f32_16x16x32_bf16 v[84:87], v[44:47], a[140:143], v[84:87]
    v_mfma_f32_16x16x32_bf16 v[68:71], v[48:51], a[136:139], v[68:71]
    v_mfma_f32_16x16x32_bf16 v[88:91], v[48:51], a[140:143], v[88:91]
    v_mfma_f32_16x16x32_bf16 v[72:75], v[52:55], a[136:139], v[72:75]
    v_mfma_f32_16x16x32_bf16 v[92:95], v[52:55], a[140:143], v[92:95]
    s_waitcnt lgkmcnt(0)
    v_mfma_f32_16x16x32_bf16 v[56:59], v[16:19], a[144:147], v[56:59]
    ds_read_b128 v[36:39], v6 offset:35840
    v_mfma_f32_16x16x32_bf16 v[76:79], v[16:19], a[148:151], v[76:79]
    ds_read_b128 v[40:43], v6 offset:36864
    v_mfma_f32_16x16x32_bf16 v[60:63], v[20:23], a[144:147], v[60:63]
    ds_read_b128 v[44:47], v6 offset:37888
    v_mfma_f32_16x16x32_bf16 v[80:83], v[20:23], a[148:151], v[80:83]
    ds_read_b128 v[48:51], v6 offset:38912
    v_mfma_f32_16x16x32_bf16 v[64:67], v[24:27], a[144:147], v[64:67]
    s_waitcnt vmcnt(0)
    ds_read_b128 v[52:55], v6 offset:39936
    v_mfma_f32_16x16x32_bf16 v[84:87], v[24:27], a[148:151], v[84:87]
    v_mfma_f32_16x16x32_bf16 v[68:71], v[28:31], a[144:147], v[68:71]
    v_mfma_f32_16x16x32_bf16 v[88:91], v[28:31], a[148:151], v[88:91]
    v_mfma_f32_16x16x32_bf16 v[72:75], v[32:35], a[144:147], v[72:75]
    v_mfma_f32_16x16x32_bf16 v[92:95], v[32:35], a[148:151], v[92:95]
    s_waitcnt lgkmcnt(0)
    v_mfma_f32_16x16x32_bf16 v[56:59], v[36:39], a[152:155], v[56:59]
    v_mfma_f32_16x16x32_bf16 v[76:79], v[36:39], a[156:159], v[76:79]
    v_mfma_f32_16x16x32_bf16 v[60:63], v[40:43], a[152:155], v[60:63]
    v_mfma_f32_16x16x32_bf16 v[80:83], v[40:43], a[156:159], v[80:83]
    v_mfma_f32_16x16x32_bf16 v[64:67], v[44:47], a[152:155], v[64:67]
    v_mfma_f32_16x16x32_bf16 v[84:87], v[44:47], a[156:159], v[84:87]
    v_mfma_f32_16x16x32_bf16 v[68:71], v[48:51], a[152:155], v[68:71]
    v_mfma_f32_16x16x32_bf16 v[88:91], v[48:51], a[156:159], v[88:91]
    v_mfma_f32_16x16x32_bf16 v[72:75], v[52:55], a[152:155], v[72:75]
    v_mfma_f32_16x16x32_bf16 v[92:95], v[52:55], a[156:159], v[92:95]
    v_cmp_u_f32 vcc, v56, v76
    s_cbranch_vccnz kA_t5r
kA_t5d:
    v_pk_mul_f32 v[138:139], v[56:57], v[56:57]
    v_pk_add_f32 v[136:137], v[56:57], v[58:59]
    v_pk_fma_f32 v[138:139], v[58:59], v[58:59], v[138:139]
    v_pk_add_f32 v[136:137], v[136:137], v[60:61]
    v_pk_fma_f32 v[138:139], v[60:61], v[60:61], v[138:139]
    v_pk_add_f32 v[136:137], v[136:137], v[62:63]
    v_pk_fma_f32 v[138:139], v[62:63], v[62:63], v[138:139]
    v_pk_add_f32 v[136:137], v[136:137], v[64:65]
    v_pk_fma_f32 v[138:139], v[64:65], v[64:65], v[138:139]
    v_pk_mul_f32 v[142:143], v[76:77], v[76:77]
    v_pk_add_f32 v[140:141], v[76:77], v[78:79]
    v_pk_fma_f32 v[142:143], v[78:79], v[78:79], v[142:143]
    v_pk_add_f32 v[140:141], v[140:141], v[80:81]
    v_pk_fma_f32 v[142:143], v[80:81], v[80:81], v[142:143]
    v_pk_add_f32 v[140:141], v[140:141], v[82:83]
    v_pk_fma_f32 v[142:143], v[82:83], v[82:83], v[142:143]
    v_pk_add_f32 v[140:141], v[140:141], v[84:85]
    v_pk_fma_f32 v[142:143], v[84:85], v[84:85], v[142:143]
    v_add_f32 v136, v136, v137
    v_add_f32 v138, v138, v139
    v_add_f32 v140, v140, v141
    v_add_f32 v142, v142, v143
    v_cvt_pk_bf16_f32 v156, v56, v57
    v_cvt_pk_bf16_f32 v157, v58, v59
    v_cvt_pk_bf16_f32 v158, v60, v61
    v_cvt_pk_bf16_f32 v159, v62, v63
    v_cvt_pk_bf16_f32 v164, v64, v65
    v_cvt_pk_bf16_f32 v160, v76, v77
    v_cvt_pk_bf16_f32 v161, v78, v79
    v_cvt_pk_bf16_f32 v162, v80, v81
    v_cvt_pk_bf16_f32 v163, v82, v83
    v_cvt_pk_bf16_f32 v165, v84, v85
    v_permlane32_swap_b32 v136, v140
    v_permlane32_swap_b32 v138, v142
    s_add_u32 s3, s46, 8683520
    buffer_store_dwordx4 v[156:159], v236, s[12:15], s3 offen sc1
    v_add_f32 v136, v136, v140
    v_add_f32 v138, v138, v142
    v_permlane16_swap_b32 v164, v165
    buffer_store_dwordx4 v[160:163], v237, s[12:15], s3 offen sc1
    v_mov_b32 v140, v136
    v_mov_b32 v141, v138
    s_add_u32 s34, s59, 8192
    buffer_store_dwordx2 v[164:165], v238, s[12:15], s3 offen sc1
    v_permlane16_swap_b32 v136, v140
    v_permlane16_swap_b32 v138, v141
    v_cvt_pk_bf16_f32 v96, v66, v86
    v_cvt_pk_bf16_f32 v97, v67, v87
    v_cvt_pk_bf16_f32 v98, v68, v88
    v_cvt_pk_bf16_f32 v99, v69, v89
    v_cvt_pk_bf16_f32 v100, v70, v90
    v_cvt_pk_bf16_f32 v101, v71, v91
    v_cvt_pk_bf16_f32 v102, v72, v92
    v_cvt_pk_bf16_f32 v103, v73, v93
    v_cvt_pk_bf16_f32 v104, v74, v94
    v_cvt_pk_bf16_f32 v105, v75, v95
    v_add_f32 v136, v136, v140
    v_add_f32 v138, v138, v141
    ds_write_b32 v254, v96 offset:0
    ds_write_b32 v254, v97 offset:544
    ds_write_b32 v254, v98 offset:1088
    ds_write_b32 v254, v99 offset:1632
    ds_write_b32 v254, v100 offset:2176
    ds_write_b32 v254, v101 offset:2720
    ds_write_b32 v254, v102 offset:3264
    ds_write_b32 v254, v103 offset:3808
    ds_write_b32 v254, v104 offset:4352
    ds_write_b32 v254, v105 offset:4896
    v_cmp_lt_u32 vcc, 63, v0
    s_nop 1
    v_cndmask_b32 v234, 0, 32, vcc
    v_add_u32 v234, v234, v239
    buffer_atomic_add_f32 v136, v242, s[12:15], s59 offen
    buffer_atomic_add_f32 v138, v242, s[12:15], s34 offen
    s_waitcnt lgkmcnt(0)
    s_barrier
    ds_read_b128 v[110:113], v239 offset:0
    ds_read_b128 v[114:117], v234 offset:4352
    ds_read_b128 v[118:121], v239 offset:8736
    s_waitcnt lgkmcnt(2)
    buffer_store_dwordx4 v[110:113], v255, s[12:15], s60 offen sc1
    s_add_u32 s60, s60, 65536
    s_waitcnt lgkmcnt(1)
    buffer_store_dwordx4 v[114:117], v255, s[12:15], s60 offen sc1
    s_add_u32 s60, s60, 65536
    s_waitcnt lgkmcnt(0)
    buffer_store_dwordx4 v[118:121], v243, s[12:15], s60 offen sc1
kA_end:
    s_endpgm
kA_t5r:
    s_add_u32 s33, s33, 1
    s_cmp_ge_u32 s33, 1024
    s_cbranch_scc1 kA_t5d
    s_waitcnt vmcnt(0)
    s_branch kA_t5
kA_kn:
    s_mov_b32 s42, 16384
kA_knl:
    s_sub_u32 s47, s61, 61440
    buffer_load_dwordx4 v[56:59], v250, s[12:15], s47 offen sc1
    s_sub_u32 s47, s61, 57344
    buffer_load_dwordx4 v[60:63], v250, s[12:15], s47 offen sc1
    s_sub_u32 s47, s61, 53248
    buffer_load_dwordx4 v[64:67], v250, s[12:15], s47 offen sc1
    s_sub_u32 s47, s61, 49152
    buffer_load_dwordx4 v[68:71], v250, s[12:15], s47 offen sc1
    s_sub_u32 s47, s61, 45056
    buffer_load_dwordx4 v[72:75], v250, s[12:15], s47 offen sc1
    s_sub_u32 s47, s61, 40960
    buffer_load_dwordx4 v[76:79], v250, s[12:15], s47 offen sc1
    s_sub_u32 s47, s61, 36864
    buffer_load_dwordx4 v[80:83], v250, s[12:15], s47 offen sc1
    s_sub_u32 s47, s61, 32768
    buffer_load_dwordx4 v[84:87], v250, s[12:15], s47 offen sc1
    s_sub_u32 s47, s61, 28672
    buffer_load_dwordx4 v[88:91], v250, s[12:15], s47 offen sc1
    s_sub_u32 s47, s61, 24576
    buffer_load_dwordx4 v[92:95], v250, s[12:15], s47 offen sc1
    s_sub_u32 s47, s61, 20480
    buffer_load_dwordx4 v[216:219], v250, s[12:15], s47 offen sc1
    s_sub_u32 s47, s61, 16384
    buffer_load_dwordx4 v[220:223], v250, s[12:15], s47 offen sc1
    s_sub_u32 s47, s61, 12288
    buffer_load_dwordx4 v[224:227], v250, s[12:15], s47 offen sc1
    s_sub_u32 s47, s61, 8192
    buffer_load_dwordx4 v[228:231], v250, s[12:15], s47 offen sc1
    s_sub_u32 s47, s61, 4096
    buffer_load_dwordx4 v[136:139], v250, s[12:15], s47 offen sc1
    s_sub_u32 s47, s61, 0
    buffer_load_dwordx4 v[140:143], v250, s[12:15], s47 offen sc1
    s_waitcnt vmcnt(0)
    v_mfma_f32_16x16x32_bf16 v[144:147], v[210:213], v[56:59], 0
    v_mfma_f32_16x16x32_bf16 v[148:151], v[208:211], v[56:59], 0
    v_mfma_f32_16x16x32_bf16 v[144:147], v[210:213], v[60:63], v[144:147]
    v_mfma_f32_16x16x32_bf16 v[148:151], v[208:211], v[60:63], v[148:151]
    v_mfma_f32_16x16x32_bf16 v[144:147], v[210:213], v[64:67], v[144:147]
    v_mfma_f32_16x16x32_bf16 v[148:151], v[208:211], v[64:67], v[148:151]
    v_mfma_f32_16x16x32_bf16 v[144:147], v[210:213], v[68:71], v[144:147]
    v_mfma_f32_16x16x32_bf16 v[148:151], v[208:211], v[68:71], v[148:151]
    v_mfma_f32_16x16x32_bf16 v[144:147], v[210:213], v[72:75], v[144:147]
    v_mfma_f32_16x16x32_bf16 v[148:151], v[208:211], v[72:75], v[148:151]
    v_mfma_f32_16x16x32_bf16 v[144:147], v[210:213], v[76:79], v[144:147]
    v_mfma_f32_16x16x32_bf16 v[148:151], v[208:211], v[76:79], v[148:151]
    v_mfma_f32_16x16x32_bf16 v[144:147], v[210:213], v[80:83], v[144:147]
    v_mfma_f32_16x16x32_bf16 v[148:151], v[208:211], v[80:83], v[148:151]
    v_mfma_f32_16x16x32_bf16 v[144:147], v[210:213], v[84:87], v[144:147]
    v_mfma_f32_16x16x32_bf16 v[148:151], v[208:211], v[84:87], v[148:151]
    v_mfma_f32_16x16x32_bf16 v[144:147], v[210:213], v[88:91], v[144:147]
    v_mfma_f32_16x16x32_bf16 v[148:151], v[208:211], v[88:91], v[148:151]
    v_mfma_f32_16x16x32_bf16 v[144:147], v[210:213], v[92:95], v[144:147]
    v_mfma_f32_16x16x32_bf16 v[148:151], v[208:211], v[92:95], v[148:151]
    v_mfma_f32_16x16x32_bf16 v[144:147], v[210:213], v[216:219], v[144:147]
    v_mfma_f32_16x16x32_bf16 v[148:151], v[208:211], v[216:219], v[148:151]
    v_mfma_f32_16x16x32_bf16 v[144:147], v[210:213], v[220:223], v[144:147]
    v_mfma_f32_16x16x32_bf16 v[148:151], v[208:211], v[220:223], v[148:151]
    v_mfma_f32_16x16x32_bf16 v[144:147], v[210:213], v[224:227], v[144:147]
    v_mfma_f32_16x16x32_bf16 v[148:151], v[208:211], v[224:227], v[148:151]
    v_mfma_f32_16x16x32_bf16 v[144:147], v[210:213], v[228:231], v[144:147]
    v_mfma_f32_16x16x32_bf16 v[148:151], v[208:211], v[228:231], v[148:151]
    v_mfma_f32_16x16x32_bf16 v[144:147], v[210:213], v[136:139], v[144:147]
    v_mfma_f32_16x16x32_bf16 v[148:151], v[208:211], v[136:139], v[148:151]
    v_mfma_f32_16x16x32_bf16 v[144:147], v[210:213], v[140:143], v[144:147]
    v_mfma_f32_16x16x32_bf16 v[148:151], v[208:211], v[140:143], v[148:151]
    s_nop 7
    v_cmp_u_f32 vcc, v144, v148
    s_cbranch_vccz kA_knd
    s_sub_u32 s42, s42, 1
    s_cmp_lg_u32 s42, 0
    s_cbranch_scc1 kA_knl
    s_branch kA_knd
kA_gw:
    s_mov_b32 s42, 65536
    s_mov_b32 s47, 4997120
kA_gwl:
    buffer_load_dword v235, v234, s[12:15], s47 offen sc1
    s_waitcnt vmcnt(0)
    v_cmp_gt_u32 vcc, 16, v235
    s_cbranch_vccz kA_gwd
    s_sub_u32 s42, s42, 1
    s_cmp_lg_u32 s42, 0
    s_cbranch_scc1 kA_gwl
    s_branch kA_gwd
kA_rt0:
    s_mov_b32 s42, 16384
kA_rl0:
    s_mov_b32 s47, 0
    s_mov_b32 s43, 20480
    buffer_load_dwordx4 a[0:3], v5, s[4:7], s47 offen sc1
    buffer_load_dwordx4 a[4:7], v5, s[4:7], s43 offen sc1
    s_mov_b32 s47, 1024
    s_mov_b32 s43, 21504
    buffer_load_dwordx4 a[8:11], v5, s[4:7], s47 offen sc1
    buffer_load_dwordx4 a[12:15], v5, s[4:7], s43 offen sc1
    s_mov_b32 s47, 2048
    s_mov_b32 s43, 22528
    buffer_load_dwordx4 a[16:19], v5, s[4:7], s47 offen sc1
    buffer_load_dwordx4 a[20:23], v5, s[4:7], s43 offen sc1
    s_mov_b32 s47, 3072
    s_mov_b32 s43, 23552
    buffer_load_dwordx4 a[24:27], v5, s[4:7], s47 offen sc1
    buffer_load_dwordx4 a[28:31], v5, s[4:7], s43 offen sc1
    s_waitcnt vmcnt(0)
    v_accvgpr_read_b32 v8, a0
    v_accvgpr_read_b32 v9, a2
    v_accvgpr_read_b32 v10, a4
    v_accvgpr_read_b32 v11, a6
    v_max_u32 v8, v8, v9
    v_max3_u32 v8, v8, v10, v11
    v_cmp_eq_u32 vcc, -1, v8
    s_cbranch_vccz kA_c0
    s_sub_u32 s42, s42, 1
    s_cmp_lg_u32 s42, 0
    s_cbranch_scc1 kA_rl0
    s_branch kA_c0
kA_rt1:
    s_mov_b32 s42, 16384
kA_rl1:
    s_mov_b32 s47, 1024
    s_mov_b32 s43, 21504
    buffer_load_dwordx4 a[8:11], v5, s[4:7], s47 offen sc1
    buffer_load_dwordx4 a[12:15], v5, s[4:7], s43 offen sc1
    s_mov_b32 s47, 2048
    s_mov_b32 s43, 22528
    buffer_load_dwordx4 a[16:19], v5, s[4:7], s47 offen sc1
    buffer_load_dwordx4 a[20:23], v5, s[4:7], s43 offen sc1
    s_mov_b32 s47, 3072
    s_mov_b32 s43, 23552
    buffer_load_dwordx4 a[24:27], v5, s[4:7], s47 offen sc1
    buffer_load_dwordx4 a[28:31], v5, s[4:7], s43 offen sc1
    s_mov_b32 s47, 4096
    s_mov_b32 s43, 24576
    buffer_load_dwordx4 a[32:35], v5, s[4:7], s47 offen sc1
    buffer_load_dwordx4 a[36:39], v5, s[4:7], s43 offen sc1
    s_waitcnt vmcnt(0)
    v_accvgpr_read_b32 v8, a8
    v_accvgpr_read_b32 v9, a10
    v_accvgpr_read_b32 v10, a12
    v_accvgpr_read_b32 v11, a14
    v_max_u32 v8, v8, v9
    v_max3_u32 v8, v8, v10, v11
    v_cmp_eq_u32 vcc, -1, v8
    s_cbranch_vccz kA_c1
    s_sub_u32 s42, s42, 1
    s_cmp_lg_u32 s42, 0
    s_cbranch_scc1 kA_rl1
    s_branch kA_c1
kA_rt2:
    s_mov_b32 s42, 16384
kA_rl2:
    s_mov_b32 s47, 2048
    s_mov_b32 s43, 22528
    buffer_load_dwordx4 a[16:19], v5, s[4:7], s47 offen sc1
    buffer_load_dwordx4 a[20:23], v5, s[4:7], s43 offen sc1
    s_mov_b32 s47, 3072
    s_mov_b32 s43, 23552
    buffer_load_dwordx4 a[24:27], v5, s[4:7], s47 offen sc1
    buffer_load_dwordx4 a[28:31], v5, s[4:7], s43 offen sc1
    s_mov_b32 s47, 4096
    s_mov_b32 s43, 24576
    buffer_load_dwordx4 a[32:35], v5, s[4:7], s47 offen sc1
    buffer_load_dwordx4 a[36:39], v5, s[4:7], s43 offen sc1
    s_mov_b32 s47, 5120
    s_mov_b32 s43, 25600
    buffer_load_dwordx4 a[40:43], v5, s[4:7], s47 offen sc1
    buffer_load_dwordx4 a[44:47], v5, s[4:7], s43 offen sc1
    s_waitcnt vmcnt(0)
    v_accvgpr_read_b32 v8, a16
    v_accvgpr_read_b32 v9, a18
    v_accvgpr_read_b32 v10, a20
    v_accvgpr_read_b32 v11, a22
    v_max_u32 v8, v8, v9
    v_max3_u32 v8, v8, v10, v11
    v_cmp_eq_u32 vcc, -1, v8
    s_cbranch_vccz kA_c2
    s_sub_u32 s42, s42, 1
    s_cmp_lg_u32 s42, 0
    s_cbranch_scc1 kA_rl2
    s_branch kA_c2
kA_rt3:
    s_mov_b32 s42, 16384
kA_rl3:
    s_mov_b32 s47, 3072
    s_mov_b32 s43, 23552
    buffer_load_dwordx4 a[24:27], v5, s[4:7], s47 offen sc1
    buffer_load_dwordx4 a[28:31], v5, s[4:7], s43 offen sc1
    s_mov_b32 s47, 4096
    s_mov_b32 s43, 24576
    buffer_load_dwordx4 a[32:35], v5, s[4:7], s47 offen sc1
    buffer_load_dwordx4 a[36:39], v5, s[4:7], s43 offen sc1
    s_mov_b32 s47, 5120
    s_mov_b32 s43, 25600
    buffer_load_dwordx4 a[40:43], v5, s[4:7], s47 offen sc1
    buffer_load_dwordx4 a[44:47], v5, s[4:7], s43 offen sc1
    s_mov_b32 s47, 6144
    s_mov_b32 s43, 26624
    buffer_load_dwordx4 a[48:51], v5, s[4:7], s47 offen sc1
    buffer_load_dwordx4 a[52:55], v5, s[4:7], s43 offen sc1
    s_waitcnt vmcnt(0)
    v_accvgpr_read_b32 v8, a24
    v_accvgpr_read_b32 v9, a26
    v_accvgpr_read_b32 v10, a28
    v_accvgpr_read_b32 v11, a30
    v_max_u32 v8, v8, v9
    v_max3_u32 v8, v8, v10, v11
    v_cmp_eq_u32 vcc, -1, v8
    s_cbranch_vccz kA_c3
    s_sub_u32 s42, s42, 1
    s_cmp_lg_u32 s42, 0
    s_cbranch_scc1 kA_rl3
    s_branch kA_c3
kA_rt4:
    s_mov_b32 s42, 16384
kA_rl4:
    s_mov_b32 s47, 4096
    s_mov_b32 s43, 24576
    buffer_load_dwordx4 a[32:35], v5, s[4:7], s47 offen sc1
    buffer_load_dwordx4 a[36:39], v5, s[4:7], s43 offen sc1
    s_mov_b32 s47, 5120
    s_mov_b32 s43, 25600
    buffer_load_dwordx4 a[40:43], v5, s[4:7], s47 offen sc1
    buffer_load_dwordx4 a[44:47], v5, s[4:7], s43 offen sc1
    s_mov_b32 s47, 6144
    s_mov_b32 s43, 26624
    buffer_load_dwordx4 a[48:51], v5, s[4:7], s47 offen sc1
    buffer_load_dwordx4 a[52:55], v5, s[4:7], s43 offen sc1
    s_mov_b32 s47, 7168
    s_mov_b32 s43, 27648
    buffer_load_dwordx4 a[56:59], v5, s[4:7], s47 offen sc1
    buffer_load_dwordx4 a[60:63], v5, s[4:7], s43 offen sc1
    s_waitcnt vmcnt(0)
    v_accvgpr_read_b32 v8, a32
    v_accvgpr_read_b32 v9, a34
    v_accvgpr_read_b32 v10, a36
    v_accvgpr_read_b32 v11, a38
    v_max_u32 v8, v8, v9
    v_max3_u32 v8, v8, v10, v11
    v_cmp_eq_u32 vcc, -1, v8
    s_cbranch_vccz kA_c4
    s_sub_u32 s42, s42, 1
    s_cmp_lg_u32 s42, 0
    s_cbranch_scc1 kA_rl4
    s_branch kA_c4
kA_rt5:
    s_mov_b32 s42, 16384
kA_rl5:
    s_mov_b32 s47, 5120
    s_mov_b32 s43, 25600
    buffer_load_dwordx4 a[40:43], v5, s[4:7], s47 offen sc1
    buffer_load_dwordx4 a[44:47], v5, s[4:7], s43 offen sc1
    s_mov_b32 s47, 6144
    s_mov_b32 s43, 26624
    buffer_load_dwordx4 a[48:51], v5, s[4:7], s47 offen sc1
    buffer_load_dwordx4 a[52:55], v5, s[4:7], s43 offen sc1
    s_mov_b32 s47, 7168
    s_mov_b32 s43, 27648
    buffer_load_dwordx4 a[56:59], v5, s[4:7], s47 offen sc1
    buffer_load_dwordx4 a[60:63], v5, s[4:7], s43 offen sc1
    s_mov_b32 s47, 8192
    s_mov_b32 s43, 28672
    buffer_load_dwordx4 a[64:67], v5, s[4:7], s47 offen sc1
    buffer_load_dwordx4 a[68:71], v5, s[4:7], s43 offen sc1
    s_waitcnt vmcnt(0)
    v_accvgpr_read_b32 v8, a40
    v_accvgpr_read_b32 v9, a42
    v_accvgpr_read_b32 v10, a44
    v_accvgpr_read_b32 v11, a46
    v_max_u32 v8, v8, v9
    v_max3_u32 v8, v8, v10, v11
    v_cmp_eq_u32 vcc, -1, v8
    s_cbranch_vccz kA_c5
    s_sub_u32 s42, s42, 1
    s_cmp_lg_u32 s42, 0
    s_cbranch_scc1 kA_rl5
    s_branch kA_c5
.text
.globl k3l0_kernel
.p2align 8
.type k3l0_kernel,@function
k3l0_kernel:
    s_cmp_ge_u32 s2, 160
    s_cbranch_scc1 k3l0_kernel_end
    s_load_dwordx2 s[30:31], s[0:1], 88
    s_and_b32 s16, s2, 7
    s_lshr_b32 s17, s2, 3
    s_lshr_b32 s19, s17, 2
    s_lshl_b32 s19, s19, 3
    s_add_u32 s16, s16, s19
    s_and_b32 s17, s17, 3
    v_and_b32 v1, 63, v0
    v_lshrrev_b32 v2, 6, v0
    s_nop 0
    v_readfirstlane_b32 s18, v2
    v_and_b32 v2, 15, v1
    v_lshrrev_b32 v3, 4, v1
    v_lshlrev_b32 v5, 4, v1
    v_lshlrev_b32 v6, 4, v0
    v_mov_b32 v20, 1073741824
    v_cmp_gt_u32 vcc, 512, v0
    s_nop 1
    v_cndmask_b32 v7, v20, v6, vcc
    s_lshl_b32 s3, s16, 3
    s_add_u32 s3, s3, s18
    s_sub_u32 s20, s3, 1
    s_lshl_b32 s20, s20, 13
    s_add_u32 s20, s20, 11304960
    s_cmp_eq_u32 s3, 0
    s_cselect_b32 s3, 1073741824, 0
    v_add_u32 v4, s3, v5
    s_add_u32 s21, s20, 4096
    s_mov_b32 s22, 4980736
    s_mov_b32 s23, 4988928
    s_waitcnt lgkmcnt(0)
    s_mov_b32 s12, s30
    s_mov_b32 s13, s31
    s_mov_b32 s14, 28114944
    s_mov_b32 s15, 0x20000
    buffer_load_dwordx4 v[8:11], v7, s[12:15], s22 offen
    buffer_load_dwordx4 v[12:15], v7, s[12:15], s23 offen
    s_cmp_ge_u32 s18, 7
    s_cbranch_scc1 k3l0_kernel_notab
    s_lshl_b32 s3, s18, 1
    s_lshl_b32 s19, s3, 10
    s_mul_i32 s33, s17, 6144
    s_add_u32 s33, s33, 4915200
    s_lshl_b32 s34, s17, 12
    s_add_u32 s34, s34, 4933632
    s_cmp_ge_u32 s3, 6
    s_cselect_b32 s33, s34, s33
    s_cmp_ge_u32 s3, 10
    s_cselect_b32 s33, 4945920, s33
    s_add_u32 s33, s33, s19
    s_add_u32 m0, s19, 34048
    s_nop 0
    buffer_load_dwordx4 v5, s[12:15], s33 offen lds
    s_lshl_b32 s3, s18, 1
    s_add_u32 s3, s3, 1
    s_lshl_b32 s19, s3, 10
    s_mul_i32 s33, s17, 6144
    s_add_u32 s33, s33, 4915200
    s_lshl_b32 s34, s17, 12
    s_add_u32 s34, s34, 4933632
    s_cmp_ge_u32 s3, 6
    s_cselect_b32 s33, s34, s33
    s_cmp_ge_u32 s3, 10
    s_cselect_b32 s33, 4945920, s33
    s_add_u32 s33, s33, s19
    s_add_u32 m0, s19, 34048
    s_nop 0
    buffer_load_dwordx4 v5, s[12:15], s33 offen lds
k3l0_kernel_notab:
    s_mov_b32 s36, s20
    s_mov_b32 s37, s21
    s_mov_b32 s28, 0xffff0000
    buffer_load_dwordx4 v[32:35], v4, s[12:15], s36 offen offset:0
    buffer_load_dwordx4 v[36:39], v4, s[12:15], s37 offen offset:0
    buffer_load_dwordx4 v[40:43], v4, s[12:15], s36 offen offset:1024
    buffer_load_dwordx4 v[44:47], v4, s[12:15], s37 offen offset:1024
    v_lshrrev_b32 v16, 5, v0
    v_and_b32 v17, 31, v0
    v_lshl_add_u32 v16, v17, 6, v16
    s_lshl_b32 s3, s17, 4
    v_add_u32 v16, s3, v16
    v_sub_u32 v17, 2048, v16
    v_and_b32 v17, 2047, v17
    v_and_b32 v22, 31, v16
    v_lshrrev_b32 v21, 5, v16
    v_lshrrev_b32 v18, 2, v22
    v_lshlrev_b32 v18, 4, v18
    v_and_b32 v22, 3, v22
    v_lshl_add_u32 v18, v22, 1, v18
    v_lshrrev_b32 v22, 5, v21
    v_lshl_add_u32 v18, v22, 3, v18
    v_and_b32 v22, 1, v21
    v_add_u32 v18, v18, v22
    v_mul_u32_u24 v18, 20480, v18
    v_bfe_u32 v22, v21, 1, 4
    v_lshl_add_u32 v18, v22, 4, v18
    v_and_b32 v22, 31, v17
    v_lshrrev_b32 v21, 5, v17
    v_lshrrev_b32 v19, 2, v22
    v_lshlrev_b32 v19, 4, v19
    v_and_b32 v22, 3, v22
    v_lshl_add_u32 v19, v22, 1, v19
    v_lshrrev_b32 v22, 5, v21
    v_lshl_add_u32 v19, v22, 3, v19
    v_and_b32 v22, 1, v21
    v_add_u32 v19, v19, v22
    v_mul_u32_u24 v19, 20480, v19
    v_bfe_u32 v22, v21, 1, 4
    v_lshl_add_u32 v19, v22, 4, v19
    v_cmp_gt_u32 vcc, 512, v0
    s_nop 1
    v_cndmask_b32 v18, v20, v18, vcc
    v_cndmask_b32 v19, v20, v19, vcc
    s_lshl_b32 s20, s16, 8
    s_sub_u32 s22, 20224, s20
    s_add_u32 s21, s20, 8683520
    s_add_u32 s23, s22, 8683520
    s_waitcnt vmcnt(4)
    v_mul_f32 v8, 0.0015625, v8
    v_mul_f32 v12, 0.0015625, v12
    v_fma_f32 v12, -v8, v8, v12
    v_max_f32 v12, 0, v12
    v_add_f32 v12, 0x3727c5ac, v12
    v_rsq_f32 v12, v12
    v_mul_f32 v9, 0.0015625, v9
    v_mul_f32 v13, 0.0015625, v13
    v_fma_f32 v13, -v9, v9, v13
    v_max_f32 v13, 0, v13
    v_add_f32 v13, 0x3727c5ac, v13
    v_rsq_f32 v13, v13
    v_mul_f32 v10, 0.0015625, v10
    v_mul_f32 v14, 0.0015625, v14
    v_fma_f32 v14, -v10, v10, v14
    v_max_f32 v14, 0, v14
    v_add_f32 v14, 0x3727c5ac, v14
    v_rsq_f32 v14, v14
    v_mul_f32 v11, 0.0015625, v11
    v_mul_f32 v15, 0.0015625, v15
    v_fma_f32 v15, -v11, v11, v15
    v_max_f32 v15, 0, v15
    v_add_f32 v15, 0x3727c5ac, v15
    v_rsq_f32 v15, v15
    v_lshrrev_b32 v8, 4, v0
    v_mul_u32_u24 v8, 272, v8
    v_and_b32 v9, 15, v0
    v_lshl_add_u32 v8, v9, 4, v8
    s_cmp_eq_u32 s18, 8
    s_cbranch_scc1 k3l0_kernel_nor
    ds_write_b128 v8, v[12:15]
k3l0_kernel_nor:
    s_waitcnt lgkmcnt(0)
    s_barrier
    buffer_load_dwordx4 v[48:51], v4, s[12:15], s36 offen offset:2048
    buffer_load_dwordx4 v[52:55], v4, s[12:15], s37 offen offset:2048
    buffer_load_dwordx4 v[56:59], v4, s[12:15], s36 offen offset:3072
    buffer_load_dwordx4 v[60:63], v4, s[12:15], s37 offen offset:3072
    buffer_load_dwordx4 v[24:27], v18, s[12:15], s21 offen
    buffer_load_dwordx4 v[28:31], v19, s[12:15], s23 offen
    v_mul_u32_u24 v8, 272, v2
    v_lshl_add_u32 v8, v3, 5, v8
    v_add_u32 v9, 34048, v5
    ds_read_b128 v[64:67], v8 offset:0
    ds_read_b128 v[68:71], v8 offset:16
    ds_read_b128 v[72:75], v8 offset:128
    ds_read_b128 v[76:79], v8 offset:144
    ds_read_b128 v[80:83], v8 offset:4352
    ds_read_b128 v[84:87], v8 offset:4368
    ds_read_b128 v[88:91], v8 offset:4480
    ds_read_b128 v[92:95], v8 offset:4496
    ds_read_b128 v[96:99], v9 offset:0
    ds_read_b128 v[100:103], v9 offset:1024
    ds_read_b128 v[104:107], v9 offset:2048
    ds_read_b128 v[108:111], v9 offset:3072
    ds_read_b128 v[112:115], v9 offset:4096
    ds_read_b128 v[116:119], v9 offset:5120
    s_waitcnt vmcnt(8) lgkmcnt(6)
    v_lshlrev_b32 v20, 16, v32
    v_and_b32 v21, s28, v32
    v_pk_mul_f32 v[20:21], v[20:21], v[64:65]
    v_cvt_pk_bf16_f32 v32, v20, v21
    v_lshlrev_b32 v22, 16, v33
    v_and_b32 v23, s28, v33
    v_pk_mul_f32 v[22:23], v[22:23], v[66:67]
    v_cvt_pk_bf16_f32 v33, v22, v23
    v_lshlrev_b32 v20, 16, v34
    v_and_b32 v21, s28, v34
    v_pk_mul_f32 v[20:21], v[20:21], v[68:69]
    v_cvt_pk_bf16_f32 v34, v20, v21
    v_lshlrev_b32 v22, 16, v35
    v_and_b32 v23, s28, v35
    v_pk_mul_f32 v[22:23], v[22:23], v[70:71]
    v_cvt_pk_bf16_f32 v35, v22, v23
    v_lshlrev_b32 v20, 16, v36
    v_and_b32 v21, s28, v36
    v_pk_mul_f32 v[20:21], v[20:21], v[64:65]
    v_cvt_pk_bf16_f32 v36, v20, v21
    v_lshlrev_b32 v22, 16, v37
    v_and_b32 v23, s28, v37
    v_pk_mul_f32 v[22:23], v[22:23], v[66:67]
    v_cvt_pk_bf16_f32 v37, v22, v23
    v_lshlrev_b32 v20, 16, v38
    v_and_b32 v21, s28, v38
    v_pk_mul_f32 v[20:21], v[20:21], v[68:69]
    v_cvt_pk_bf16_f32 v38, v20, v21
    v_lshlrev_b32 v22, 16, v39
    v_and_b32 v23, s28, v39
    v_pk_mul_f32 v[22:23], v[22:23], v[70:71]
    v_cvt_pk_bf16_f32 v39, v22, v23
    s_waitcnt vmcnt(6)
    ds_read_b128 v[120:123], v9 offset:6144
    ds_read_b128 v[124:127], v9 offset:7168
    ds_read_b128 v[128:131], v9 offset:8192
    ds_read_b128 v[132:135], v9 offset:9216
    ds_read_b128 v[136:139], v9 offset:10240
    ds_read_b128 v[140:143], v9 offset:11264
    ds_read_b128 v[144:147], v9 offset:12288
    ds_read_b128 v[148:151], v9 offset:13312
    v_lshlrev_b32 v20, 16, v40
    v_and_b32 v21, s28, v40
    v_pk_mul_f32 v[20:21], v[20:21], v[72:73]
    v_cvt_pk_bf16_f32 v40, v20, v21
    v_lshlrev_b32 v22, 16, v41
    v_and_b32 v23, s28, v41
    v_pk_mul_f32 v[22:23], v[22:23], v[74:75]
    v_cvt_pk_bf16_f32 v41, v22, v23
    v_lshlrev_b32 v20, 16, v42
    v_and_b32 v21, s28, v42
    v_pk_mul_f32 v[20:21], v[20:21], v[76:77]
    v_cvt_pk_bf16_f32 v42, v20, v21
    v_lshlrev_b32 v22, 16, v43
    v_and_b32 v23, s28, v43
    v_pk_mul_f32 v[22:23], v[22:23], v[78:79]
    v_cvt_pk_bf16_f32 v43, v22, v23
    v_lshlrev_b32 v20, 16, v44
    v_and_b32 v21, s28, v44
    v_pk_mul_f32 v[20:21], v[20:21], v[72:73]
    v_cvt_pk_bf16_f32 v44, v20, v21
    v_lshlrev_b32 v22, 16, v45
    v_and_b32 v23, s28, v45
    v_pk_mul_f32 v[22:23], v[22:23], v[74:75]
    v_cvt_pk_bf16_f32 v45, v22, v23
    v_lshlrev_b32 v20, 16, v46
    v_and_b32 v21, s28, v46
    v_pk_mul_f32 v[20:21], v[20:21], v[76:77]
    v_cvt_pk_bf16_f32 v46, v20, v21
    v_lshlrev_b32 v22, 16, v47
    v_and_b32 v23, s28, v47
    v_pk_mul_f32 v[22:23], v[22:23], v[78:79]
    v_cvt_pk_bf16_f32 v47, v22, v23
    s_waitcnt vmcnt(4)
    v_lshlrev_b32 v20, 16, v48
    v_and_b32 v21, s28, v48
    v_pk_mul_f32 v[20:21], v[20:21], v[80:81]
    v_cvt_pk_bf16_f32 v48, v20, v21
    v_lshlrev_b32 v22, 16, v49
    v_and_b32 v23, s28, v49
    v_pk_mul_f32 v[22:23], v[22:23], v[82:83]
    v_cvt_pk_bf16_f32 v49, v22, v23
    v_lshlrev_b32 v20, 16, v50
    v_and_b32 v21, s28, v50
    v_pk_mul_f32 v[20:21], v[20:21], v[84:85]
    v_cvt_pk_bf16_f32 v50, v20, v21
    v_lshlrev_b32 v22, 16, v51
    v_and_b32 v23, s28, v51
    v_pk_mul_f32 v[22:23], v[22:23], v[86:87]
    v_cvt_pk_bf16_f32 v51, v22, v23
    v_lshlrev_b32 v20, 16, v52
    v_and_b32 v21, s28, v52
    v_pk_mul_f32 v[20:21], v[20:21], v[80:81]
    v_cvt_pk_bf16_f32 v52, v20, v21
    v_lshlrev_b32 v22, 16, v53
    v_and_b32 v23, s28, v53
    v_pk_mul_f32 v[22:23], v[22:23], v[82:83]
    v_cvt_pk_bf16_f32 v53, v22, v23
    v_lshlrev_b32 v20, 16, v54
    v_and_b32 v21, s28, v54
    v_pk_mul_f32 v[20:21], v[20:21], v[84:85]
    v_cvt_pk_bf16_f32 v54, v20, v21
    v_lshlrev_b32 v22, 16, v55
    v_and_b32 v23, s28, v55
    v_pk_mul_f32 v[22:23], v[22:23], v[86:87]
    v_cvt_pk_bf16_f32 v55, v22, v23
    s_waitcnt vmcnt(2)
    v_lshlrev_b32 v20, 16, v56
    v_and_b32 v21, s28, v56
    v_pk_mul_f32 v[20:21], v[20:21], v[88:89]
    v_cvt_pk_bf16_f32 v56, v20, v21
    v_lshlrev_b32 v22, 16, v57
    v_and_b32 v23, s28, v57
    v_pk_mul_f32 v[22:23], v[22:23], v[90:91]
    v_cvt_pk_bf16_f32 v57, v22, v23
    v_lshlrev_b32 v20, 16, v58
    v_and_b32 v21, s28, v58
    v_pk_mul_f32 v[20:21], v[20:21], v[92:93]
    v_cvt_pk_bf16_f32 v58, v20, v21
    v_lshlrev_b32 v22, 16, v59
    v_and_b32 v23, s28, v59
    v_pk_mul_f32 v[22:23], v[22:23], v[94:95]
    v_cvt_pk_bf16_f32 v59, v22, v23
    v_lshlrev_b32 v20, 16, v60
    v_and_b32 v21, s28, v60
    v_pk_mul_f32 v[20:21], v[20:21], v[88:89]
    v_cvt_pk_bf16_f32 v60, v20, v21
    v_lshlrev_b32 v22, 16, v61
    v_and_b32 v23, s28, v61
    v_pk_mul_f32 v[22:23], v[22:23], v[90:91]
    v_cvt_pk_bf16_f32 v61, v22, v23
    v_lshlrev_b32 v20, 16, v62
    v_and_b32 v21, s28, v62
    v_pk_mul_f32 v[20:21], v[20:21], v[92:93]
    v_cvt_pk_bf16_f32 v62, v20, v21
    v_lshlrev_b32 v22, 16, v63
    v_and_b32 v23, s28, v63
    v_pk_mul_f32 v[22:23], v[22:23], v[94:95]
    v_cvt_pk_bf16_f32 v63, v22, v23
    s_waitcnt lgkmcnt(0)
    v_mfma_f32_16x16x32_bf16 v[152:155], v[32:35], v[96:99], 0
    v_mfma_f32_16x16x32_bf16 v[156:159], v[32:35], v[104:107], 0
    v_mfma_f32_16x16x32_bf16 v[152:155], v[40:43], v[100:103], v[152:155]
    v_mfma_f32_16x16x32_bf16 v[156:159], v[40:43], v[108:111], v[156:159]
    v_mfma_f32_16x16x32_bf16 v[152:155], v[36:39], v[112:115], v[152:155]
    v_mfma_f32_16x16x32_bf16 v[156:159], v[36:39], v[96:99], v[156:159]
    v_mfma_f32_16x16x32_bf16 v[152:155], v[44:47], v[116:119], v[152:155]
    v_mfma_f32_16x16x32_bf16 v[156:159], v[44:47], v[100:103], v[156:159]
    v_mfma_f32_16x16x32_bf16 v[160:163], v[48:51], v[96:99], 0
    v_mfma_f32_16x16x32_bf16 v[164:167], v[48:51], v[104:107], 0
    v_mfma_f32_16x16x32_bf16 v[160:163], v[56:59], v[100:103], v[160:163]
    v_mfma_f32_16x16x32_bf16 v[164:167], v[56:59], v[108:111], v[164:167]
    v_mfma_f32_16x16x32_bf16 v[160:163], v[52:55], v[112:115], v[160:163]
    v_mfma_f32_16x16x32_bf16 v[164:167], v[52:55], v[96:99], v[164:167]
    v_mfma_f32_16x16x32_bf16 v[160:163], v[60:63], v[116:119], v[160:163]
    v_mfma_f32_16x16x32_bf16 v[164:167], v[60:63], v[100:103], v[164:167]
    v_mul_f32 v32, v152, v120
    v_mul_f32 v40, v156, v120
    v_fmac_f32 v32, v156, v128
    v_fma_f32 v40, -v152, v128, v40
    v_mul_f32 v33, v153, v121
    v_mul_f32 v41, v157, v121
    v_fmac_f32 v33, v157, v129
    v_fma_f32 v41, -v153, v129, v41
    v_mul_f32 v34, v154, v122
    v_mul_f32 v42, v158, v122
    v_fmac_f32 v34, v158, v130
    v_fma_f32 v42, -v154, v130, v42
    v_mul_f32 v35, v155, v123
    v_mul_f32 v43, v159, v123
    v_fmac_f32 v35, v159, v131
    v_fma_f32 v43, -v155, v131, v43
    v_mul_f32 v36, v160, v124
    v_mul_f32 v44, v164, v124
    v_fmac_f32 v36, v164, v132
    v_fma_f32 v44, -v160, v132, v44
    v_mul_f32 v37, v161, v125
    v_mul_f32 v45, v165, v125
    v_fmac_f32 v37, v165, v133
    v_fma_f32 v45, -v161, v133, v45
    v_mul_f32 v38, v162, v126
    v_mul_f32 v46, v166, v126
    v_fmac_f32 v38, v166, v134
    v_fma_f32 v46, -v162, v134, v46
    v_mul_f32 v39, v163, v127
    v_mul_f32 v47, v167, v127
    v_fmac_f32 v39, v167, v135
    v_fma_f32 v47, -v163, v135, v47
    v_cvt_pk_bf16_f32 v48, v32, v33
    v_cvt_pk_bf16_f32 v52, v40, v41
    v_cvt_pk_bf16_f32 v49, v34, v35
    v_cvt_pk_bf16_f32 v53, v42, v43
    v_cvt_pk_bf16_f32 v50, v36, v37
    v_cvt_pk_bf16_f32 v54, v44, v45
    v_cvt_pk_bf16_f32 v51, v38, v39
    v_cvt_pk_bf16_f32 v55, v46, v47
    v_mul_u32_u24 v8, 33, v2
    v_lshl_add_u32 v8, v3, 2, v8
    v_mul_u32_u24 v8, 48, v8
    s_lshl_b32 s3, s18, 2
    s_add_u32 s3, s3, 8704
    v_add_u32 v8, s3, v8
    v_mfma_f32_16x16x32_bf16 v[56:59], v[136:139], v[48:51], 0
    v_mfma_f32_16x16x32_bf16 v[60:63], v[144:147], v[48:51], 0
    v_mfma_f32_16x16x32_bf16 v[56:59], v[140:143], v[52:55], v[56:59]
    v_mfma_f32_16x16x32_bf16 v[60:63], v[148:151], v[52:55], v[60:63]
    s_nop 6
    ds_write_b32 v8, v56 offset:0
    ds_write_b32 v8, v57 offset:48
    ds_write_b32 v8, v58 offset:96
    ds_write_b32 v8, v59 offset:144
    ds_write_b32 v8, v60 offset:768
    ds_write_b32 v8, v61 offset:816
    ds_write_b32 v8, v62 offset:864
    ds_write_b32 v8, v63 offset:912
    s_waitcnt lgkmcnt(0)
    s_barrier
    s_cmp_eq_u32 s18, 8
    s_cbranch_scc1 k3l0_kernel_end
    v_lshrrev_b32 v8, 5, v0
    v_mul_u32_u24 v8, 33, v8
    v_and_b32 v9, 31, v0
    v_add_u32 v8, v8, v9
    v_mul_u32_u24 v8, 48, v8
    ds_read_b128 v[32:35], v8 offset:8704
    ds_read_b128 v[36:39], v8 offset:8720
    ds_read_b32 v64, v8 offset:8736
    s_waitcnt vmcnt(0)
    v_lshlrev_b32 v40, 16, v24
    v_and_b32 v41, s28, v24
    v_lshlrev_b32 v48, 16, v28
    v_and_b32 v49, s28, v28
    v_lshlrev_b32 v42, 16, v25
    v_and_b32 v43, s28, v25
    v_lshlrev_b32 v50, 16, v29
    v_and_b32 v51, s28, v29
    v_lshlrev_b32 v44, 16, v26
    v_and_b32 v45, s28, v26
    v_lshlrev_b32 v52, 16, v30
    v_and_b32 v53, s28, v30
    v_lshlrev_b32 v46, 16, v27
    v_and_b32 v47, s28, v27
    v_lshlrev_b32 v54, 16, v31
    v_and_b32 v55, s28, v31
    s_waitcnt lgkmcnt(0)
    v_add_f32 v40, v40, v32
    v_add_f32 v48, v48, v64
    v_add_f32 v41, v41, v33
    v_add_f32 v49, v49, v39
    v_add_f32 v42, v42, v34
    v_add_f32 v50, v50, v38
    v_add_f32 v43, v43, v35
    v_add_f32 v51, v51, v37
    v_add_f32 v44, v44, v36
    v_add_f32 v52, v52, v36
    v_add_f32 v45, v45, v37
    v_add_f32 v53, v53, v35
    v_add_f32 v46, v46, v38
    v_add_f32 v54, v54, v34
    v_add_f32 v47, v47, v39
    v_add_f32 v55, v55, v33
    v_cvt_pk_bf16_f32 v56, v40, v41
    v_cvt_pk_bf16_f32 v60, v48, v49
    v_cvt_pk_bf16_f32 v57, v42, v43
    v_cvt_pk_bf16_f32 v61, v50, v51
    v_cvt_pk_bf16_f32 v58, v44, v45
    v_cvt_pk_bf16_f32 v62, v52, v53
    v_cvt_pk_bf16_f32 v59, v46, v47
    v_cvt_pk_bf16_f32 v63, v54, v55
    s_add_u32 s21, s20, 25493504
    s_add_u32 s23, s22, 25493504
    buffer_store_dwordx4 v[56:59], v18, s[12:15], s21 offen sc1
    buffer_store_dwordx4 v[60:63], v19, s[12:15], s23 offen sc1
k3l0_kernel_end:
    s_endpgm
.text
.globl k3l1_kernel
.p2align 8
.type k3l1_kernel,@function
k3l1_kernel:
    s_cmp_ge_u32 s2, 256
    s_cbranch_scc1 k3l1_kernel_end
    s_and_b32 s16, s2, 7
    s_cmp_ge_u32 s16, 5
    s_cbranch_scc1 k3l1_kernel_end
    s_load_dwordx2 s[30:31], s[0:1], 88
    s_load_dwordx2 s[24:25], s[0:1], 72
    s_lshr_b32 s17, s2, 3
    s_lshl_b32 s16, s16, 3
    s_and_b32 s19, s17, 7
    s_add_u32 s16, s16, s19
    s_lshr_b32 s17, s17, 3
    v_and_b32 v1, 63, v0
    v_lshrrev_b32 v2, 6, v0
    s_nop 0
    v_readfirstlane_b32 s18, v2
    v_and_b32 v2, 15, v1
    v_lshrrev_b32 v3, 4, v1
    v_lshlrev_b32 v5, 4, v1
    v_lshlrev_b32 v6, 4, v0
    v_mov_b32 v20, 1073741824
    v_cmp_gt_u32 vcc, 512, v0
    s_nop 1
    v_cndmask_b32 v7, v20, v6, vcc
    s_lshl_b32 s3, s16, 3
    s_add_u32 s3, s3, s18
    s_sub_u32 s20, s3, 1
    s_lshl_b32 s20, s20, 13
    s_add_u32 s20, s20, 22872064
    s_cmp_eq_u32 s3, 0
    s_cselect_b32 s3, 1073741824, 0
    v_add_u32 v4, s3, v5
    s_add_u32 s21, s20, 4096
    s_mov_b32 s22, 16547840
    s_mov_b32 s23, 16556032
    s_waitcnt lgkmcnt(0)
    s_mov_b32 s12, s30
    s_mov_b32 s13, s31
    s_mov_b32 s14, 28114944
    s_mov_b32 s15, 0x20000
    buffer_load_dwordx4 v[8:11], v7, s[12:15], s22 offen
    buffer_load_dwordx4 v[12:15], v7, s[12:15], s23 offen
    s_cmp_ge_u32 s18, 7
    s_cbranch_scc1 k3l1_kernel_notab
    s_lshl_b32 s3, s18, 1
    s_lshl_b32 s19, s3, 10
    s_mul_i32 s33, s17, 6144
    s_add_u32 s33, s33, 4915200
    s_lshl_b32 s34, s17, 12
    s_add_u32 s34, s34, 4933632
    s_cmp_ge_u32 s3, 6
    s_cselect_b32 s33, s34, s33
    s_cmp_ge_u32 s3, 10
    s_cselect_b32 s33, 4945920, s33
    s_add_u32 s33, s33, s19
    s_add_u32 m0, s19, 34048
    s_nop 0
    buffer_load_dwordx4 v5, s[12:15], s33 offen lds
    s_lshl_b32 s3, s18, 1
    s_add_u32 s3, s3, 1
    s_lshl_b32 s19, s3, 10
    s_mul_i32 s33, s17, 6144
    s_add_u32 s33, s33, 4915200
    s_lshl_b32 s34, s17, 12
    s_add_u32 s34, s34, 4933632
    s_cmp_ge_u32 s3, 6
    s_cselect_b32 s33, s34, s33
    s_cmp_ge_u32 s3, 10
    s_cselect_b32 s33, 4945920, s33
    s_add_u32 s33, s33, s19
    s_add_u32 m0, s19, 34048
    s_nop 0
    buffer_load_dwordx4 v5, s[12:15], s33 offen lds
k3l1_kernel_notab:
    s_mov_b32 s36, s20
    s_mov_b32 s37, s21
    s_mov_b32 s28, 0xffff0000
    buffer_load_dwordx4 v[32:35], v4, s[12:15], s36 offen offset:0
    buffer_load_dwordx4 v[36:39], v4, s[12:15], s37 offen offset:0
    buffer_load_dwordx4 v[40:43], v4, s[12:15], s36 offen offset:1024
    buffer_load_dwordx4 v[44:47], v4, s[12:15], s37 offen offset:1024
    v_lshrrev_b32 v16, 5, v0
    v_and_b32 v17, 31, v0
    v_lshl_add_u32 v16, v17, 6, v16
    s_lshl_b32 s3, s17, 4
    v_add_u32 v16, s3, v16
    v_sub_u32 v17, 2048, v16
    v_and_b32 v17, 2047, v17
    v_and_b32 v22, 31, v16
    v_lshrrev_b32 v21, 5, v16
    v_lshrrev_b32 v18, 2, v22
    v_lshlrev_b32 v18, 4, v18
    v_and_b32 v22, 3, v22
    v_lshl_add_u32 v18, v22, 1, v18
    v_lshrrev_b32 v22, 5, v21
    v_lshl_add_u32 v18, v22, 3, v18
    v_and_b32 v22, 1, v21
    v_add_u32 v18, v18, v22
    v_mul_u32_u24 v18, 20480, v18
    v_bfe_u32 v22, v21, 1, 4
    v_lshl_add_u32 v18, v22, 4, v18
    v_and_b32 v22, 31, v17
    v_lshrrev_b32 v21, 5, v17
    v_lshrrev_b32 v19, 2, v22
    v_lshlrev_b32 v19, 4, v19
    v_and_b32 v22, 3, v22
    v_lshl_add_u32 v19, v22, 1, v19
    v_lshrrev_b32 v22, 5, v21
    v_lshl_add_u32 v19, v22, 3, v19
    v_and_b32 v22, 1, v21
    v_add_u32 v19, v19, v22
    v_mul_u32_u24 v19, 20480, v19
    v_bfe_u32 v22, v21, 1, 4
    v_lshl_add_u32 v19, v22, 4, v19
    v_cmp_gt_u32 vcc, 512, v0
    s_nop 1
    v_cndmask_b32 v18, v20, v18, vcc
    v_cndmask_b32 v19, v20, v19, vcc
    s_lshl_b32 s20, s16, 8
    s_sub_u32 s22, 20224, s20
    s_add_u32 s21, s20, 20250624
    s_add_u32 s23, s22, 20250624
    s_waitcnt vmcnt(4)
    v_mul_f32 v8, 0.0015625, v8
    v_mul_f32 v12, 0.0015625, v12
    v_fma_f32 v12, -v8, v8, v12
    v_max_f32 v12, 0, v12
    v_add_f32 v12, 0x3727c5ac, v12
    v_rsq_f32 v12, v12
    v_mul_f32 v9, 0.0015625, v9
    v_mul_f32 v13, 0.0015625, v13
    v_fma_f32 v13, -v9, v9, v13
    v_max_f32 v13, 0, v13
    v_add_f32 v13, 0x3727c5ac, v13
    v_rsq_f32 v13, v13
    v_mul_f32 v10, 0.0015625, v10
    v_mul_f32 v14, 0.0015625, v14
    v_fma_f32 v14, -v10, v10, v14
    v_max_f32 v14, 0, v14
    v_add_f32 v14, 0x3727c5ac, v14
    v_rsq_f32 v14, v14
    v_mul_f32 v11, 0.0015625, v11
    v_mul_f32 v15, 0.0015625, v15
    v_fma_f32 v15, -v11, v11, v15
    v_max_f32 v15, 0, v15
    v_add_f32 v15, 0x3727c5ac, v15
    v_rsq_f32 v15, v15
    v_lshrrev_b32 v8, 4, v0
    v_mul_u32_u24 v8, 272, v8
    v_and_b32 v9, 15, v0
    v_lshl_add_u32 v8, v9, 4, v8
    s_cmp_eq_u32 s18, 8
    s_cbranch_scc1 k3l1_kernel_nor
    ds_write_b128 v8, v[12:15]
k3l1_kernel_nor:
    s_waitcnt lgkmcnt(0)
    s_barrier
    buffer_load_dwordx4 v[48:51], v4, s[12:15], s36 offen offset:2048
    buffer_load_dwordx4 v[52:55], v4, s[12:15], s37 offen offset:2048
    buffer_load_dwordx4 v[56:59], v4, s[12:15], s36 offen offset:3072
    buffer_load_dwordx4 v[60:63], v4, s[12:15], s37 offen offset:3072
    buffer_load_dwordx4 v[24:27], v18, s[12:15], s21 offen
    buffer_load_dwordx4 v[28:31], v19, s[12:15], s23 offen
    v_mul_u32_u24 v8, 272, v2
    v_lshl_add_u32 v8, v3, 5, v8
    v_add_u32 v9, 34048, v5
    ds_read_b128 v[64:67], v8 offset:0
    ds_read_b128 v[68:71], v8 offset:16
    ds_read_b128 v[72:75], v8 offset:128
    ds_read_b128 v[76:79], v8 offset:144
    ds_read_b128 v[80:83], v8 offset:4352
    ds_read_b128 v[84:87], v8 offset:4368
    ds_read_b128 v[88:91], v8 offset:4480
    ds_read_b128 v[92:95], v8 offset:4496
    ds_read_b128 v[96:99], v9 offset:0
    ds_read_b128 v[100:103], v9 offset:1024
    ds_read_b128 v[104:107], v9 offset:2048
    ds_read_b128 v[108:111], v9 offset:3072
    ds_read_b128 v[112:115], v9 offset:4096
    ds_read_b128 v[116:119], v9 offset:5120
    s_waitcnt vmcnt(8) lgkmcnt(6)
    v_lshlrev_b32 v20, 16, v32
    v_and_b32 v21, s28, v32
    v_pk_mul_f32 v[20:21], v[20:21], v[64:65]
    v_cvt_pk_bf16_f32 v32, v20, v21
    v_lshlrev_b32 v22, 16, v33
    v_and_b32 v23, s28, v33
    v_pk_mul_f32 v[22:23], v[22:23], v[66:67]
    v_cvt_pk_bf16_f32 v33, v22, v23
    v_lshlrev_b32 v20, 16, v34
    v_and_b32 v21, s28, v34
    v_pk_mul_f32 v[20:21], v[20:21], v[68:69]
    v_cvt_pk_bf16_f32 v34, v20, v21
    v_lshlrev_b32 v22, 16, v35
    v_and_b32 v23, s28, v35
    v_pk_mul_f32 v[22:23], v[22:23], v[70:71]
    v_cvt_pk_bf16_f32 v35, v22, v23
    v_lshlrev_b32 v20, 16, v36
    v_and_b32 v21, s28, v36
    v_pk_mul_f32 v[20:21], v[20:21], v[64:65]
    v_cvt_pk_bf16_f32 v36, v20, v21
    v_lshlrev_b32 v22, 16, v37
    v_and_b32 v23, s28, v37
    v_pk_mul_f32 v[22:23], v[22:23], v[66:67]
    v_cvt_pk_bf16_f32 v37, v22, v23
    v_lshlrev_b32 v20, 16, v38
    v_and_b32 v21, s28, v38
    v_pk_mul_f32 v[20:21], v[20:21], v[68:69]
    v_cvt_pk_bf16_f32 v38, v20, v21
    v_lshlrev_b32 v22, 16, v39
    v_and_b32 v23, s28, v39
    v_pk_mul_f32 v[22:23], v[22:23], v[70:71]
    v_cvt_pk_bf16_f32 v39, v22, v23
    s_waitcnt vmcnt(6)
    ds_read_b128 v[120:123], v9 offset:6144
    ds_read_b128 v[124:127], v9 offset:7168
    ds_read_b128 v[128:131], v9 offset:8192
    ds_read_b128 v[132:135], v9 offset:9216
    ds_read_b128 v[136:139], v9 offset:10240
    ds_read_b128 v[140:143], v9 offset:11264
    ds_read_b128 v[144:147], v9 offset:12288
    ds_read_b128 v[148:151], v9 offset:13312
    v_lshlrev_b32 v20, 16, v40
    v_and_b32 v21, s28, v40
    v_pk_mul_f32 v[20:21], v[20:21], v[72:73]
    v_cvt_pk_bf16_f32 v40, v20, v21
    v_lshlrev_b32 v22, 16, v41
    v_and_b32 v23, s28, v41
    v_pk_mul_f32 v[22:23], v[22:23], v[74:75]
    v_cvt_pk_bf16_f32 v41, v22, v23
    v_lshlrev_b32 v20, 16, v42
    v_and_b32 v21, s28, v42
    v_pk_mul_f32 v[20:21], v[20:21], v[76:77]
    v_cvt_pk_bf16_f32 v42, v20, v21
    v_lshlrev_b32 v22, 16, v43
    v_and_b32 v23, s28, v43
    v_pk_mul_f32 v[22:23], v[22:23], v[78:79]
    v_cvt_pk_bf16_f32 v43, v22, v23
    v_lshlrev_b32 v20, 16, v44
    v_and_b32 v21, s28, v44
    v_pk_mul_f32 v[20:21], v[20:21], v[72:73]
    v_cvt_pk_bf16_f32 v44, v20, v21
    v_lshlrev_b32 v22, 16, v45
    v_and_b32 v23, s28, v45
    v_pk_mul_f32 v[22:23], v[22:23], v[74:75]
    v_cvt_pk_bf16_f32 v45, v22, v23
    v_lshlrev_b32 v20, 16, v46
    v_and_b32 v21, s28, v46
    v_pk_mul_f32 v[20:21], v[20:21], v[76:77]
    v_cvt_pk_bf16_f32 v46, v20, v21
    v_lshlrev_b32 v22, 16, v47
    v_and_b32 v23, s28, v47
    v_pk_mul_f32 v[22:23], v[22:23], v[78:79]
    v_cvt_pk_bf16_f32 v47, v22, v23
    s_waitcnt vmcnt(4)
    v_lshlrev_b32 v20, 16, v48
    v_and_b32 v21, s28, v48
    v_pk_mul_f32 v[20:21], v[20:21], v[80:81]
    v_cvt_pk_bf16_f32 v48, v20, v21
    v_lshlrev_b32 v22, 16, v49
    v_and_b32 v23, s28, v49
    v_pk_mul_f32 v[22:23], v[22:23], v[82:83]
    v_cvt_pk_bf16_f32 v49, v22, v23
    v_lshlrev_b32 v20, 16, v50
    v_and_b32 v21, s28, v50
    v_pk_mul_f32 v[20:21], v[20:21], v[84:85]
    v_cvt_pk_bf16_f32 v50, v20, v21
    v_lshlrev_b32 v22, 16, v51
    v_and_b32 v23, s28, v51
    v_pk_mul_f32 v[22:23], v[22:23], v[86:87]
    v_cvt_pk_bf16_f32 v51, v22, v23
    v_lshlrev_b32 v20, 16, v52
    v_and_b32 v21, s28, v52
    v_pk_mul_f32 v[20:21], v[20:21], v[80:81]
    v_cvt_pk_bf16_f32 v52, v20, v21
    v_lshlrev_b32 v22, 16, v53
    v_and_b32 v23, s28, v53
    v_pk_mul_f32 v[22:23], v[22:23], v[82:83]
    v_cvt_pk_bf16_f32 v53, v22, v23
    v_lshlrev_b32 v20, 16, v54
    v_and_b32 v21, s28, v54
    v_pk_mul_f32 v[20:21], v[20:21], v[84:85]
    v_cvt_pk_bf16_f32 v54, v20, v21
    v_lshlrev_b32 v22, 16, v55
    v_and_b32 v23, s28, v55
    v_pk_mul_f32 v[22:23], v[22:23], v[86:87]
    v_cvt_pk_bf16_f32 v55, v22, v23
    s_waitcnt vmcnt(2)
    v_lshlrev_b32 v20, 16, v56
    v_and_b32 v21, s28, v56
    v_pk_mul_f32 v[20:21], v[20:21], v[88:89]
    v_cvt_pk_bf16_f32 v56, v20, v21
    v_lshlrev_b32 v22, 16, v57
    v_and_b32 v23, s28, v57
    v_pk_mul_f32 v[22:23], v[22:23], v[90:91]
    v_cvt_pk_bf16_f32 v57, v22, v23
    v_lshlrev_b32 v20, 16, v58
    v_and_b32 v21, s28, v58
    v_pk_mul_f32 v[20:21], v[20:21], v[92:93]
    v_cvt_pk_bf16_f32 v58, v20, v21
    v_lshlrev_b32 v22, 16, v59
    v_and_b32 v23, s28, v59
    v_pk_mul_f32 v[22:23], v[22:23], v[94:95]
    v_cvt_pk_bf16_f32 v59, v22, v23
    v_lshlrev_b32 v20, 16, v60
    v_and_b32 v21, s28, v60
    v_pk_mul_f32 v[20:21], v[20:21], v[88:89]
    v_cvt_pk_bf16_f32 v60, v20, v21
    v_lshlrev_b32 v22, 16, v61
    v_and_b32 v23, s28, v61
    v_pk_mul_f32 v[22:23], v[22:23], v[90:91]
    v_cvt_pk_bf16_f32 v61, v22, v23
    v_lshlrev_b32 v20, 16, v62
    v_and_b32 v21, s28, v62
    v_pk_mul_f32 v[20:21], v[20:21], v[92:93]
    v_cvt_pk_bf16_f32 v62, v20, v21
    v_lshlrev_b32 v22, 16, v63
    v_and_b32 v23, s28, v63
    v_pk_mul_f32 v[22:23], v[22:23], v[94:95]
    v_cvt_pk_bf16_f32 v63, v22, v23
    s_waitcnt lgkmcnt(0)
    v_mfma_f32_16x16x32_bf16 v[152:155], v[32:35], v[96:99], 0
    v_mfma_f32_16x16x32_bf16 v[156:159], v[32:35], v[104:107], 0
    v_mfma_f32_16x16x32_bf16 v[152:155], v[40:43], v[100:103], v[152:155]
    v_mfma_f32_16x16x32_bf16 v[156:159], v[40:43], v[108:111], v[156:159]
    v_mfma_f32_16x16x32_bf16 v[152:155], v[36:39], v[112:115], v[152:155]
    v_mfma_f32_16x16x32_bf16 v[156:159], v[36:39], v[96:99], v[156:159]
    v_mfma_f32_16x16x32_bf16 v[152:155], v[44:47], v[116:119], v[152:155]
    v_mfma_f32_16x16x32_bf16 v[156:159], v[44:47], v[100:103], v[156:159]
    v_mfma_f32_16x16x32_bf16 v[160:163], v[48:51], v[96:99], 0
    v_mfma_f32_16x16x32_bf16 v[164:167], v[48:51], v[104:107], 0
    v_mfma_f32_16x16x32_bf16 v[160:163], v[56:59], v[100:103], v[160:163]
    v_mfma_f32_16x16x32_bf16 v[164:167], v[56:59], v[108:111], v[164:167]
    v_mfma_f32_16x16x32_bf16 v[160:163], v[52:55], v[112:115], v[160:163]
    v_mfma_f32_16x16x32_bf16 v[164:167], v[52:55], v[96:99], v[164:167]
    v_mfma_f32_16x16x32_bf16 v[160:163], v[60:63], v[116:119], v[160:163]
    v_mfma_f32_16x16x32_bf16 v[164:167], v[60:63], v[100:103], v[164:167]
    v_mul_f32 v32, v152, v120
    v_mul_f32 v40, v156, v120
    v_fmac_f32 v32, v156, v128
    v_fma_f32 v40, -v152, v128, v40
    v_mul_f32 v33, v153, v121
    v_mul_f32 v41, v157, v121
    v_fmac_f32 v33, v157, v129
    v_fma_f32 v41, -v153, v129, v41
    v_mul_f32 v34, v154, v122
    v_mul_f32 v42, v158, v122
    v_fmac_f32 v34, v158, v130
    v_fma_f32 v42, -v154, v130, v42
    v_mul_f32 v35, v155, v123
    v_mul_f32 v43, v159, v123
    v_fmac_f32 v35, v159, v131
    v_fma_f32 v43, -v155, v131, v43
    v_mul_f32 v36, v160, v124
    v_mul_f32 v44, v164, v124
    v_fmac_f32 v36, v164, v132
    v_fma_f32 v44, -v160, v132, v44
    v_mul_f32 v37, v161, v125
    v_mul_f32 v45, v165, v125
    v_fmac_f32 v37, v165, v133
    v_fma_f32 v45, -v161, v133, v45
    v_mul_f32 v38, v162, v126
    v_mul_f32 v46, v166, v126
    v_fmac_f32 v38, v166, v134
    v_fma_f32 v46, -v162, v134, v46
    v_mul_f32 v39, v163, v127
    v_mul_f32 v47, v167, v127
    v_fmac_f32 v39, v167, v135
    v_fma_f32 v47, -v163, v135, v47
    v_cvt_pk_bf16_f32 v48, v32, v33
    v_cvt_pk_bf16_f32 v52, v40, v41
    v_cvt_pk_bf16_f32 v49, v34, v35
    v_cvt_pk_bf16_f32 v53, v42, v43
    v_cvt_pk_bf16_f32 v50, v36, v37
    v_cvt_pk_bf16_f32 v54, v44, v45
    v_cvt_pk_bf16_f32 v51, v38, v39
    v_cvt_pk_bf16_f32 v55, v46, v47
    v_mul_u32_u24 v8, 33, v2
    v_lshl_add_u32 v8, v3, 2, v8
    v_mul_u32_u24 v8, 48, v8
    s_lshl_b32 s3, s18, 2
    s_add_u32 s3, s3, 8704
    v_add_u32 v8, s3, v8
    v_mfma_f32_16x16x32_bf16 v[56:59], v[136:139], v[48:51], 0
    v_mfma_f32_16x16x32_bf16 v[60:63], v[144:147], v[48:51], 0
    v_mfma_f32_16x16x32_bf16 v[56:59], v[140:143], v[52:55], v[56:59]
    v_mfma_f32_16x16x32_bf16 v[60:63], v[148:151], v[52:55], v[60:63]
    s_nop 6
    ds_write_b32 v8, v56 offset:0
    ds_write_b32 v8, v57 offset:48
    ds_write_b32 v8, v58 offset:96
    ds_write_b32 v8, v59 offset:144
    ds_write_b32 v8, v60 offset:768
    ds_write_b32 v8, v61 offset:816
    ds_write_b32 v8, v62 offset:864
    ds_write_b32 v8, v63 offset:912
    s_waitcnt lgkmcnt(0)
    s_barrier
    s_cmp_eq_u32 s18, 8
    s_cbranch_scc1 k3l1_kernel_end
    v_lshrrev_b32 v8, 5, v0
    v_mul_u32_u24 v8, 33, v8
    v_and_b32 v9, 31, v0
    v_add_u32 v8, v8, v9
    v_mul_u32_u24 v8, 48, v8
    ds_read_b128 v[32:35], v8 offset:8704
    ds_read_b128 v[36:39], v8 offset:8720
    ds_read_b32 v64, v8 offset:8736
    s_waitcnt vmcnt(0)
    v_lshlrev_b32 v40, 16, v24
    v_and_b32 v41, s28, v24
    v_lshlrev_b32 v48, 16, v28
    v_and_b32 v49, s28, v28
    v_lshlrev_b32 v42, 16, v25
    v_and_b32 v43, s28, v25
    v_lshlrev_b32 v50, 16, v29
    v_and_b32 v51, s28, v29
    v_lshlrev_b32 v44, 16, v26
    v_and_b32 v45, s28, v26
    v_lshlrev_b32 v52, 16, v30
    v_and_b32 v53, s28, v30
    v_lshlrev_b32 v46, 16, v27
    v_and_b32 v47, s28, v27
    v_lshlrev_b32 v54, 16, v31
    v_and_b32 v55, s28, v31
    s_waitcnt lgkmcnt(0)
    v_add_f32 v40, v40, v32
    v_add_f32 v48, v48, v64
    v_add_f32 v41, v41, v33
    v_add_f32 v49, v49, v39
    v_add_f32 v42, v42, v34
    v_add_f32 v50, v50, v38
    v_add_f32 v43, v43, v35
    v_add_f32 v51, v51, v37
    v_add_f32 v44, v44, v36
    v_add_f32 v52, v52, v36
    v_add_f32 v45, v45, v37
    v_add_f32 v53, v53, v35
    v_add_f32 v46, v46, v38
    v_add_f32 v54, v54, v34
    v_add_f32 v47, v47, v39
    v_add_f32 v55, v55, v33
    v_cvt_pk_bf16_f32 v56, v40, v41
    v_cvt_pk_bf16_f32 v60, v48, v49
    v_cvt_pk_bf16_f32 v57, v42, v43
    v_cvt_pk_bf16_f32 v61, v50, v51
    v_cvt_pk_bf16_f32 v58, v44, v45
    v_cvt_pk_bf16_f32 v62, v52, v53
    v_cvt_pk_bf16_f32 v59, v46, v47
    v_cvt_pk_bf16_f32 v63, v54, v55
    s_mov_b32 s26, 2621440
    s_mov_b32 s27, 0x20000
    v_mul_u32_u24 v18, 1280, v16
    v_mul_u32_u24 v19, 1280, v17
    s_lshl_b32 s20, s16, 4
    s_sub_u32 s22, 1264, s20
    buffer_store_dwordx4 v[56:59], v18, s[24:27], s20 offen
    buffer_store_dwordx4 v[60:63], v19, s[24:27], s22 offen
k3l1_kernel_end:
    s_endpgm
.text
prog_end:
    s_endpgm
.section .rodata,"a"
.p2align 6
.amdhsa_kernel k0_kernel
  .amdhsa_next_free_vgpr 256
  .amdhsa_next_free_sgpr 72
  .amdhsa_accum_offset 256
  .amdhsa_group_segment_fixed_size 0
  .amdhsa_kernarg_size 96
  .amdhsa_user_sgpr_count 2
  .amdhsa_user_sgpr_kernarg_segment_ptr 1
  .amdhsa_system_sgpr_workgroup_id_x 1
  .amdhsa_float_denorm_mode_32 3
.end_amdhsa_kernel
.section .rodata,"a"
.p2align 6
.amdhsa_kernel kAl0_kernel
  .amdhsa_next_free_vgpr 416
  .amdhsa_next_free_sgpr 72
  .amdhsa_accum_offset 256
  .amdhsa_group_segment_fixed_size 0
  .amdhsa_kernarg_size 96
  .amdhsa_user_sgpr_count 2
  .amdhsa_user_sgpr_kernarg_segment_ptr 1
  .amdhsa_system_sgpr_workgroup_id_x 1
  .amdhsa_float_denorm_mode_32 3
.end_amdhsa_kernel
.section .rodata,"a"
.p2align 6
.amdhsa_kernel kAl1_kernel
  .amdhsa_next_free_vgpr 416
  .amdhsa_next_free_sgpr 72
  .amdhsa_accum_offset 256
  .amdhsa_group_segment_fixed_size 0
  .amdhsa_kernarg_size 96
  .amdhsa_user_sgpr_count 2
  .amdhsa_user_sgpr_kernarg_segment_ptr 1
  .amdhsa_system_sgpr_workgroup_id_x 1
  .amdhsa_float_denorm_mode_32 3
.end_amdhsa_kernel
.section .rodata,"a"
.p2align 6
.amdhsa_kernel k3l0_kernel
  .amdhsa_next_free_vgpr 168
  .amdhsa_next_free_sgpr 64
  .amdhsa_accum_offset 168
  .amdhsa_group_segment_fixed_size 0
  .amdhsa_kernarg_size 96
  .amdhsa_user_sgpr_count 2
  .amdhsa_user_sgpr_kernarg_segment_ptr 1
  .amdhsa_system_sgpr_workgroup_id_x 1
  .amdhsa_float_denorm_mode_32 3
.end_amdhsa_kernel
.section .rodata,"a"
.p2align 6
.amdhsa_kernel k3l1_kernel
  .amdhsa_next_free_vgpr 168
  .amdhsa_next_free_sgpr 64
  .amdhsa_accum_offset 168
  .amdhsa_group_segment_fixed_size 0
  .amdhsa_kernarg_size 96
  .amdhsa_user_sgpr_count 2
  .amdhsa_user_sgpr_kernarg_segment_ptr 1
  .amdhsa_system_sgpr_workgroup_id_x 1
  .amdhsa_float_denorm_mode_32 3
.end_amdhsa_kernel
```
